```python
import torch

def _softmax(x, axis=-1):
    return torch.softmax(x, dim=axis)
def _gelu(x):
    return torch.nn.functional.gelu(x, approximate="tanh")
def _silu(x):
    return torch.nn.functional.silu(x)
def _sigmoid(x):
    return torch.sigmoid(x)
def _layernorm(x, axis=-1, eps=1e-5):
    m = x.mean(dim=axis, keepdim=True)
    v = x.var(dim=axis, keepdim=True, unbiased=False)
    return (x - m) / torch.sqrt(v + eps)
def _scatter_add(tgt, idx, src, axis=0):
    return tgt.clone().index_add_(axis, idx, src)
def _segment_sum(src, seg, n):
    out = torch.zeros((n,) + src.shape[1:], dtype=src.dtype)
    return out.index_add_(0, seg, src)
def _pad(x, pw):
    flat = tuple(v for pair in reversed(pw) for v in pair)
    return torch.nn.functional.pad(x, flat)

kernel_name = 'concat_heads__mha_block_cached__mha_block_cached__decode'

def setup_inputs():

    _w = (lambda a: (lambda t: t.to(torch.bfloat16) if t.is_floating_point() else t)(torch.as_tensor(a)))
    def _A_setup():
        B, Sq, D = 2, 1, 448
        H, Sk, Dh = 16, 4096, 256
        return {
            "x": _w((lambda *s: torch.randn(*s, dtype=torch.bfloat16) * 0.8)(B, Sq, D)),
            "k_cache": _w((lambda *s: torch.randn(*s, dtype=torch.bfloat16) * 0.8)(B, H, Sk, Dh)),
            "v_cache": _w((lambda *s: torch.randn(*s, dtype=torch.bfloat16) * 0.05)(B, H, Sk, Dh)),
            "wq": _w((lambda *s: torch.randn(*s, dtype=torch.bfloat16) * 0.8)(D, H * Dh) * (D ** -0.5)),
            "wo": _w((lambda *s: torch.randn(*s, dtype=torch.bfloat16) * 0.05)(H * Dh, D) * ((H * Dh) ** -0.5)),
        }
    _A_in = _A_setup()

    def _B_setup():
        B, Sq, D = 2, 1, 448
        H, Sk, Dh = 16, 4096, 256
        return {
            "x": _w((lambda *s: torch.randn(*s, dtype=torch.bfloat16) * 0.8)(B, Sq, D)),
            "k_cache": _w((lambda *s: torch.randn(*s, dtype=torch.bfloat16) * 0.8)(B, H, Sk, Dh)),
            "v_cache": _w((lambda *s: torch.randn(*s, dtype=torch.bfloat16) * 0.05)(B, H, Sk, Dh)),
            "wq": _w((lambda *s: torch.randn(*s, dtype=torch.bfloat16) * 0.8)(D, H * Dh) * (D ** -0.5)),
            "wo": _w((lambda *s: torch.randn(*s, dtype=torch.bfloat16) * 0.05)(H * Dh, D) * ((H * Dh) ** -0.5)),
        }
    _B_in = _B_setup()

    return {
        "A_x": _A_in["x"],
        "A_k_cache": _A_in["k_cache"],
        "A_v_cache": _A_in["v_cache"],
        "A_wq": _A_in["wq"],
        "A_wo": _A_in["wo"],
        "B_x": _B_in["x"],
        "B_k_cache": _B_in["k_cache"],
        "B_v_cache": _B_in["v_cache"],
        "B_wq": _B_in["wq"],
        "B_wo": _B_in["wo"],
    }

def reference(A_x, A_k_cache, A_v_cache, A_wq, A_wo, B_x, B_k_cache, B_v_cache, B_wq, B_wo):
    def _A_ref(x, k_cache, v_cache, wq, wo):
        B, Sq, D = x.shape
        H, Dh = 16, 256
        q = (lambda x, *d: x.permute(*d))((x @ wq).reshape(B, Sq, H, Dh), 0, 2, 1, 3)
        scores = torch.einsum("bhqd,bhkd->bhqk", q, k_cache) * (Dh ** -0.5)
        p = _softmax(scores, axis=-1)
        o = torch.einsum("bhqk,bhkd->bhqd", p, v_cache)
        return (lambda x, *d: x.permute(*d))(o, 0, 2, 1, 3).reshape(B, Sq, H * Dh) @ wo

    def _B_ref(x, k_cache, v_cache, wq, wo):
        B, Sq, D = x.shape
        H, Dh = 16, 256
        q = (lambda x, *d: x.permute(*d))((x @ wq).reshape(B, Sq, H, Dh), 0, 2, 1, 3)
        scores = torch.einsum("bhqd,bhkd->bhqk", q, k_cache) * (Dh ** -0.5)
        p = _softmax(scores, axis=-1)
        o = torch.einsum("bhqk,bhkd->bhqd", p, v_cache)
        return (lambda x, *d: x.permute(*d))(o, 0, 2, 1, 3).reshape(B, Sq, H * Dh) @ wo

    a = _A_ref(A_x, A_k_cache, A_v_cache, A_wq, A_wo)
    b = _B_ref(B_x, B_k_cache, B_v_cache, B_wq, B_wo)
    return torch.concatenate([a, b], axis=-1)
```

```asm
; @launch grid=(256,1,1) block=(512,1,1) lds=47744
.amdgcn_target "amdgcn-amd-amdhsa--gfx950"
.text
.globl concat_heads__mha_block_cached__mha_block_cached__decode_kernel
.p2align 12
.type concat_heads__mha_block_cached__mha_block_cached__decode_kernel,@function
concat_heads__mha_block_cached__mha_block_cached__decode_kernel:
    s_cmp_ge_u32 s2, 256
    s_cbranch_scc1 L_end
    s_bfe_u32 s50, s2, 0x10000
    s_mul_i32 s5, s50, 40
    s_load_dwordx2 s[24:25], s[0:1], s5 offset:8
    s_load_dwordx2 s[32:33], s[0:1], s5 offset:24
    s_load_dwordx2 s[36:37], s[0:1], s5
    s_load_dwordx2 s[40:41], s[0:1], s5 offset:32
    s_load_dwordx2 s[44:45], s[0:1], 96
    s_load_dwordx2 s[28:29], s[0:1], s5 offset:16
    s_load_dwordx2 s[52:53], s[0:1], 80
    s_lshr_b32 s3, s2, 2
    s_xor_b32 s3, s3, s2
    s_bfe_i32 s3, s3, 0x10000
    s_and_b32 s3, s3, 5
    s_xor_b32 s2, s2, s3
    v_lshrrev_b32 v3, 3, v0
    s_and_b32 s88, s2, 3
    v_and_b32 v32, 7, v0
    s_lshr_b32 s82, s2, 6
    v_lshlrev_b32 v33, 4, v32
    s_lshl2_add_u32 s88, s88, s82
    s_bfe_u32 s84, s2, 0x20004
    s_mul_i32 s84, s84, 56
    v_add_u32 v37, s84, v3
    s_bfe_u32 s83, s2, 0x10003
    s_lshl1_add_u32 s83, s88, s83
    s_lshl_b32 s83, s83, 8
    v_lshl_add_u32 v36, v37, 14, v33
    v_lshlrev_b32 v37, 2, v37
    v_add_u32 v36, s83, v36
    s_add_u32 s84, s84, 56
    s_lshl_b32 s34, s84, 14
    s_mov_b32 s35, 0x00020000
    s_movk_i32 s38, 1792
    s_mov_b32 s39, 0x00020000
    s_movk_i32 s83, 8192
    s_waitcnt lgkmcnt(0)
    s_and_b32 s25, s25, 0xffff
    s_and_b32 s37, s37, 0xffff
    buffer_load_dword v16, v37, s[36:39], 0 offen offset:0 nt
    buffer_load_dword v17, v37, s[36:39], 0 offen offset:896 nt
    s_and_b32 s33, s33, 0xffff
    buffer_load_dwordx4 v[240:243], v36, s[32:35], 0 offen offset:0 nt
    buffer_load_dwordx4 v[244:247], v36, s[32:35], 0 offen offset:128 nt
    buffer_load_dwordx4 v[248:251], v36, s[32:35], s83 offen offset:0 nt
    buffer_load_dwordx4 v[252:255], v36, s[32:35], s83 offen offset:128 nt
    v_bfe_i32 v38, v0, 3, 1
    v_and_b32 v38, 0x8e600, v38
    v_xor_b32 v1, v38, v33
    v_bfe_i32 v38, v0, 4, 1
    v_and_b32 v38, 0x30600, v38
    v_xor_b32 v1, v38, v1
    v_bfe_i32 v38, v0, 5, 1
    v_and_b32 v38, 0x10200, v38
    v_xor_b32 v1, v38, v1
    v_bfe_i32 v38, v0, 6, 1
    v_and_b32 v38, 0xa7200, v38
    v_xor_b32 v1, v38, v1
    v_bfe_i32 v38, v0, 7, 1
    v_and_b32 v38, 0xb5800, v38
    v_xor_b32 v1, v38, v1
    v_bfe_i32 v38, v0, 8, 1
    v_and_b32 v38, 0x32c00, v38
    v_xor_b32 v1, v38, v1
    s_lshl_b32 s56, s88, 21
    s_bfe_i32 s23, s2, 0x10000
    s_and_b32 s23, s23, 0x53200
    s_xor_b32 s56, s56, s23
    s_bfe_i32 s23, s2, 0x10001
    s_and_b32 s23, s23, 0x93c00
    s_xor_b32 s56, s56, s23
    s_bfe_i32 s23, s2, 0x10003
    s_and_b32 s23, s23, 0x1d800
    s_xor_b32 s56, s56, s23
    s_bfe_i32 s23, s2, 0x10004
    s_and_b32 s23, s23, 0x16c00
    s_xor_b32 s56, s56, s23
    s_bfe_i32 s23, s2, 0x10005
    s_and_b32 s23, s23, 0x2020600
    s_xor_b32 s56, s56, s23
    s_bfe_i32 s23, s2, 0x10006
    s_and_b32 s23, s23, 0x9800
    s_xor_b32 s56, s56, s23
    s_bfe_i32 s23, s2, 0x10007
    s_and_b32 s23, s23, 0x28400
    s_xor_b32 s56, s56, s23
    v_xor_b32 v1, s56, v1
    s_mov_b32 s26, 0x4000000
    s_mov_b32 s27, 0x00020000
    buffer_load_dwordx4 v[64:67], v1, s[24:27], 0 offen offset:0 nt
    v_lshrrev_b32 v34, 6, v0
    v_and_b32 v35, 63, v0
    s_bfe_u32 s86, s2, 0x20003
    v_readfirstlane_b32 s3, v34
    s_lshl2_add_u32 s80, s88, s86
    s_bfe_u32 s6, s2, 0x10005
    s_lshl1_add_u32 s79, s50, s6
    s_bfe_u32 s5, s2, 0x30003
    s_mul_i32 s9, s88, 229376
    s_lshl_b32 s89, s50, 7
    s_add_u32 s89, s89, 655360
    s_lshl4_add_u32 s4, s50, s88
    s_and_b32 s41, s41, 0xffff
    s_mov_b32 s42, 3670016
    s_mov_b32 s43, 0x00020000
    s_and_b32 s45, s45, 0xffff
    s_mov_b32 s46, 2097152
    s_mov_b32 s47, 0x00020000
    s_and_b32 s29, s29, 0xffff
    s_mov_b32 s30, 67108864
    s_mov_b32 s31, 0x00020000
    s_and_b32 s53, s53, 0xffff
    s_mov_b32 s54, 3584
    s_mov_b32 s55, 0x00020000
    s_mov_b32 s72, 0x00ff00ff
    s_mov_b32 s73, 0xff00ff00
    s_mov_b32 s78, 0x3db8aa3b
    s_lshl_b32 s64, s3, 1
    s_and_b32 s16, s2, 7
    s_lshl3_add_u32 s16, s16, s3
    s_lshl_b32 s16, s16, 8
    s_add_u32 s16, s16, 659456
    s_lshr_b32 s18, s2, 3
    s_lshl2_add_u32 s18, s18, s16
    s_or_b32 s20, s16, 0x780
    s_sub_u32 s21, s20, s16
    s_sub_u32 s21, s21, 128
    s_bfe_u32 s10, s2, 0x20003
    s_lshl_b32 s11, s10, 5
    s_add_u32 s20, s20, s11
    s_lshl_b32 s19, s2, 9
    s_add_u32 s19, s19, 524544
    s_lshr_b32 s22, s2, 5
    s_cmp_eq_u32 s3, 3
    s_cselect_b32 s22, s22, 99
    s_and_b32 s10, s2, 7
    s_mov_b64 s[68:69], 0xff
    s_bitset0_b32 s68, s10
    s_mov_b32 s70, 0
    s_lshl_b32 s63, s3, 2
    s_lshr_b32 s63, 0x10101011, s63
    s_and_b32 s63, s63, 15
    s_add_u32 s63, s63, 19
    s_mov_b32 s67, 0
    s_min_i32 s65, s63, 16
    s_max_i32 s65, s65, 0
    s_bfm_b32 s61, s65, 0
    s_mul_i32 s61, s61, 0x10001
    s_lshr_b32 s61, s61, s64
    s_sub_i32 s65, s63, 16
    s_max_i32 s65, s65, 0
    s_min_i32 s65, s65, 16
    s_bfm_b32 s62, s65, 0
    s_mul_i32 s62, s62, 0x10001
    s_lshr_b32 s62, s62, s64
    v_and_b32 v3, 63, v0
    v_lshlrev_b32 v3, 7, v3
    s_lshl3_add_u32 s23, s5, s3
    s_mul_i32 s23, s23, 3584
    s_add_u32 s23, s23, 0
    s_add_u32 s23, s23, s9
    v_cmp_gt_u32 vcc, 3584, v3
    s_nop 0
    s_mov_b64 exec, vcc
    buffer_load_dword v3, v3, s[40:43], s23 offen
    s_mov_b64 exec, -1
    s_getpc_b64 s[90:91]
L_pc:
    s_andn2_b32 s23, s2, 7
    s_or_b32 s23, s23, s3
    s_lshl_b32 s23, s23, 6
    s_min_u32 s23, s23, L_end-L_pc
    s_cmp_eq_u32 s3, 7
    s_cbranch_scc1 L_sync
    s_load_dword s48, s[44:45], s89
    s_load_dword s23, s[90:91], s23
    s_xor_b32 s83, s89, 128
    s_load_dword s8, s[44:45], s83
    v_and_b32 v38, 1, v32
    v_lshlrev_b32 v38, 4, v38
    v_mov_b32 v39, 0xffff
    v_lshlrev_b32 v38, v38, v39
    v_lshrrev_b32 v39, 1, v32
    v_cmp_eq_u32 vcc, 0, v39
    s_nop 1
    v_cndmask_b32 v4, 0, v38, vcc
    v_cmp_eq_u32 vcc, 1, v39
    s_nop 1
    v_cndmask_b32 v5, 0, v38, vcc
    v_cmp_eq_u32 vcc, 2, v39
    s_nop 1
    v_cndmask_b32 v6, 0, v38, vcc
    v_cmp_eq_u32 vcc, 3, v39
    s_nop 1
    v_cndmask_b32 v7, 0, v38, vcc
    v_bfe_u32 v38, v0, 5, 1
    v_lshlrev_b32 v2, 2, v38
    v_bfe_u32 v38, v0, 3, 1
    v_lshl_add_u32 v2, v38, 1, v2
    v_bfe_u32 v38, v0, 4, 1
    v_add_u32 v2, v38, v2
    v_mul_u32_u24 v2, 896, v2
    v_add_u32 v2, v2, v33
    s_lshl_b32 s12, s3, 7
    s_cmp_eq_u32 s3, 7
    s_cselect_b32 s12, 0x8000000, s12
    v_add_u32 v2, s12, v2
    s_mov_b32 s12, s9
    s_and_b32 s51, s3, 3
    s_mov_b32 s83, 0x01000100
    s_mov_b32 s84, 0x03020302
    v_lshrrev_b32 v41, 5, v0
    v_mul_u32_u24 v41, 1088, v41
    v_and_b32 v38, 7, v0
    v_lshl_add_u32 v41, v38, 5, v41
    v_and_b32 v38, 16, v0
    v_add_u32 v41, v41, v38
    s_barrier
    s_waitcnt vmcnt(3)
    buffer_load_dwordx4 v[68:71], v1, s[24:27], 0 offen offset:384 nt
    s_waitcnt vmcnt(3)
    buffer_load_dwordx4 v[72:75], v1, s[24:27], 0 offen offset:128 nt
    v_perm_b32 v42, v16, v16, s83
    v_and_b32 v8, v42, v4
    v_and_b32 v9, v42, v5
    v_and_b32 v10, v42, v6
    v_and_b32 v11, v42, v7
    s_nop 1
    v_mfma_f32_16x16x32_bf16 v[48:51], v[8:11], v[240:243], 0
    v_mfma_f32_16x16x32_bf16 v[52:55], v[8:11], v[244:247], 0
    v_perm_b32 v42, v17, v17, s83
    v_and_b32 v12, v42, v4
    v_and_b32 v13, v42, v5
    v_and_b32 v14, v42, v6
    v_and_b32 v15, v42, v7
    s_nop 1
    v_mfma_f32_16x16x32_bf16 v[56:59], v[12:15], v[240:243], 0
    v_mfma_f32_16x16x32_bf16 v[60:63], v[12:15], v[244:247], 0
    v_perm_b32 v42, v16, v16, s84
    v_and_b32 v8, v42, v4
    v_and_b32 v9, v42, v5
    v_and_b32 v10, v42, v6
    v_and_b32 v11, v42, v7
    s_nop 1
    v_mfma_f32_16x16x32_bf16 v[48:51], v[8:11], v[248:251], v[48:51]
    v_mfma_f32_16x16x32_bf16 v[52:55], v[8:11], v[252:255], v[52:55]
    v_perm_b32 v42, v17, v17, s84
    v_and_b32 v12, v42, v4
    v_and_b32 v13, v42, v5
    v_and_b32 v14, v42, v6
    v_and_b32 v15, v42, v7
    s_nop 1
    v_mfma_f32_16x16x32_bf16 v[56:59], v[12:15], v[248:251], v[56:59]
    v_mfma_f32_16x16x32_bf16 v[60:63], v[12:15], v[252:255], v[60:63]
    s_mov_b64 exec, s[72:73]
    ds_write_b128 v41, v[48:51] offset:0
    ds_write_b128 v41, v[52:55] offset:256
    s_nop 1
    ds_write_b128 v41, v[56:59] offset:512
    s_nop 1
    ds_write_b128 v41, v[60:63] offset:768
    s_mov_b64 exec, -1
    v_mov_b32 v38, 0
    v_mov_b32 v39, 1
    s_waitcnt lgkmcnt(0)
    s_mov_b64 exec, 1
    ds_add_u32 v38, v39 offset:47680
    s_mov_b64 exec, -1
    s_add_u32 s49, s48, 0x9e3779b9
    s_waitcnt vmcnt(3)
    buffer_load_dwordx4 v[76:79], v1, s[24:27], 0 offen offset:256 nt
    v_xor_b32 v1, 0x38600, v1
    s_waitcnt vmcnt(2)
    buffer_load_dwordx4 v[80:83], v1, s[24:27], 0 offen offset:384 nt
    s_waitcnt vmcnt(2)
    buffer_load_dwordx4 v[84:87], v1, s[24:27], 0 offen offset:0 nt
    s_waitcnt vmcnt(2)
    buffer_load_dwordx4 v[88:91], v1, s[24:27], 0 offen offset:256 nt
    s_waitcnt vmcnt(2)
    buffer_load_dwordx4 v[92:95], v1, s[24:27], 0 offen offset:128 nt
    v_xor_b32 v1, 0x94600, v1
    s_waitcnt vmcnt(2)
    buffer_load_dwordx4 v[96:99], v1, s[24:27], 0 offen offset:384 nt
    s_waitcnt vmcnt(2)
    buffer_load_dwordx4 v[100:103], v1, s[24:27], 0 offen offset:0 nt
    s_waitcnt vmcnt(2)
    buffer_load_dwordx4 v[104:107], v1, s[24:27], 0 offen offset:256 nt
    s_cmp_lg_u32 s22, 0
    s_cbranch_scc1 L_sh1
    s_lshl_b32 s10, s49, 8
    v_mov_b32 v14, s10
    s_mov_b64 exec, 1
    buffer_store_dword v14, off, s[44:47], s19 sc1
    s_mov_b64 exec, -1
L_sh1:
    s_cmp_lg_u32 s22, 0
    s_cbranch_scc1 L_sh2
    v_and_b32 v12, 7, v0
    v_lshlrev_b32 v12, 9, v12
    s_andn2_b32 s10, s19, 0xe00
    s_mov_b64 exec, s[68:69]
    buffer_load_dword v13, v12, s[44:47], s10 offen sc1
    s_mov_b64 exec, -1
L_sh2:
    s_waitcnt vmcnt(2)
    buffer_load_dwordx4 v[108:111], v1, s[24:27], 0 offen offset:128 nt
    v_xor_b32 v1, 0x38600, v1
    s_bitcmp0_b32 s61, 12
    s_cbranch_scc1 L_p1
    s_waitcnt vmcnt(2)
    s_bitcmp0_b32 s62, 12
    s_cbranch_scc1 L_p1
    s_waitcnt vmcnt(1)
L_p1:
    buffer_load_dwordx4 v[112:115], v1, s[24:27], 0 offen offset:0 nt
    s_waitcnt vmcnt(3)
    s_bitcmp0_b32 s61, 13
    s_cbranch_scc1 L_p2
    s_waitcnt vmcnt(2)
    s_bitcmp0_b32 s62, 13
    s_cbranch_scc1 L_p2
    s_waitcnt vmcnt(1)
L_p2:
    buffer_load_dwordx4 v[116:119], v1, s[24:27], 0 offen offset:384 nt
    s_waitcnt vmcnt(3)
    s_bitcmp0_b32 s61, 14
    s_cbranch_scc1 L_p3
    s_waitcnt vmcnt(2)
    s_bitcmp0_b32 s62, 14
    s_cbranch_scc1 L_p3
    s_waitcnt vmcnt(1)
L_p3:
    buffer_load_dwordx4 v[120:123], v1, s[24:27], 0 offen offset:128 nt
    s_waitcnt vmcnt(3)
    s_bitcmp0_b32 s61, 15
    s_cbranch_scc1 L_p4
    s_waitcnt vmcnt(2)
    s_bitcmp0_b32 s62, 15
    s_cbranch_scc1 L_p4
    s_waitcnt vmcnt(1)
L_p4:
    buffer_load_dwordx4 v[124:127], v1, s[24:27], 0 offen offset:256 nt
    s_cmp_lg_u32 s22, 0
    s_cbranch_scc1 L_sh3
    s_lshl_b32 s10, s8, 8
    s_add_u32 s10, s10, 0x3779b900
    v_cmp_eq_u32 vcc, s10, v13
    v_cmp_eq_u32 s[10:11], v14, v13
    v_subrev_u32 v14, 0, v14
    s_or_b64 vcc, vcc, s[10:11]
    v_lshrrev_b32 v12, 7, v12
    v_addc_co_u32 v14, vcc, 0, v14, vcc
    s_mov_b64 exec, s[68:69]
    buffer_store_dword v14, v12, s[44:47], s20 offen
    s_mov_b64 exec, -1
    s_nop 1
L_sh3:
    v_xor_b32 v1, 0x58a00, v1
    s_waitcnt vmcnt(3)
    s_bitcmp0_b32 s61, 0
    s_cbranch_scc1 L_p5
    s_waitcnt vmcnt(2)
    s_bitcmp0_b32 s62, 0
    s_cbranch_scc1 L_p5
    s_waitcnt vmcnt(1)
L_p5:
    buffer_load_dwordx4 v[128:131], v1, s[24:27], 0 offen offset:0 nt
    s_waitcnt vmcnt(3)
    s_bitcmp0_b32 s61, 1
    s_cbranch_scc1 L_p6
    s_waitcnt vmcnt(2)
    s_bitcmp0_b32 s62, 1
    s_cbranch_scc1 L_p6
    s_waitcnt vmcnt(1)
L_p6:
    buffer_load_dwordx4 v[132:135], v1, s[24:27], 0 offen offset:384 nt
    s_waitcnt vmcnt(3)
    s_bitcmp0_b32 s61, 2
    s_cbranch_scc1 L_p7
    s_waitcnt vmcnt(2)
    s_bitcmp0_b32 s62, 2
    s_cbranch_scc1 L_p7
    s_waitcnt vmcnt(1)
L_p7:
    buffer_load_dwordx4 v[136:139], v1, s[24:27], 0 offen offset:128 nt
    s_lshl_b32 s71, s49, 8
    v_mov_b32 v15, s71
    v_and_b32 v3, 63, v0
    v_lshlrev_b32 v3, 2, v3
    s_mov_b32 exec_lo, 0
    v_add_u32 v3, s21, v3
    s_mov_b64 exec, 1
    buffer_store_dword v15, off, s[44:47], s18
    s_mov_b64 exec, -1
    buffer_load_dword v3, v3, s[44:47], s16 offen
    s_waitcnt vmcnt(5)
    s_bitcmp0_b32 s61, 3
    s_cbranch_scc1 L_p8
    s_waitcnt vmcnt(4)
    s_bitcmp0_b32 s62, 3
    s_cbranch_scc1 L_p8
    s_waitcnt vmcnt(3)
L_p8:
    buffer_load_dwordx4 v[140:143], v1, s[24:27], 0 offen offset:256 nt
    v_xor_b32 v1, 0x38600, v1
    s_waitcnt vmcnt(5)
    s_bitcmp0_b32 s61, 4
    s_cbranch_scc1 L_p9
    s_waitcnt vmcnt(4)
    s_bitcmp0_b32 s62, 4
    s_cbranch_scc1 L_p9
    s_waitcnt vmcnt(3)
L_p9:
    buffer_load_dwordx4 v[144:147], v1, s[24:27], 0 offen offset:384 nt
    s_waitcnt vmcnt(5)
    s_bitcmp0_b32 s61, 5
    s_cbranch_scc1 L_p10
    s_waitcnt vmcnt(4)
    s_bitcmp0_b32 s62, 5
    s_cbranch_scc1 L_p10
    s_waitcnt vmcnt(1)
L_p10:
    buffer_load_dwordx4 v[148:151], v1, s[24:27], 0 offen offset:0 nt
    s_waitcnt vmcnt(5)
    s_bitcmp0_b32 s61, 6
    s_cbranch_scc1 L_p11
    s_waitcnt vmcnt(2)
    s_bitcmp0_b32 s62, 6
    s_cbranch_scc1 L_p11
    s_waitcnt vmcnt(1)
L_p11:
    buffer_load_dwordx4 v[152:155], v1, s[24:27], 0 offen offset:256 nt
    s_waitcnt vmcnt(3)
    s_bitcmp0_b32 s61, 7
    s_cbranch_scc1 L_p12
    s_waitcnt vmcnt(2)
    s_bitcmp0_b32 s62, 7
    s_cbranch_scc1 L_p12
    s_waitcnt vmcnt(1)
L_p12:
    buffer_load_dwordx4 v[156:159], v1, s[24:27], 0 offen offset:128 nt
    s_add_u32 s71, s71, 3
    v_sub_u32 v3, s71, v3
    s_mov_b32 exec_lo, 0
    v_add_u32 v3, 1, v3
    s_mov_b32 exec_lo, -1
    v_cmp_gt_u32 vcc, 5, v3
    v_cmp_gt_u32 s[10:11], 4, v3
    s_bcnt1_i32_b32 s7, vcc_hi
    s_bcnt1_i32_b32 s11, s11
    s_mul_i32 s7, s7, 4294967290
    s_lshl3_add_u32 s7, s11, s7
    s_mul_i32 s7, s7, 16
    s_ashr_i32 s7, s7, 3
    s_movk_i32 s70, 32
    v_cmp_gt_u32 vcc, 3, v3
    s_bcnt1_i32_b32 s10, s10
    s_add_u32 s70, s70, s10
    s_bcnt1_i32_b32 s10, vcc_lo
    s_add_u32 s70, s70, s10
    s_sub_i32 s70, s70, 45
    s_mul_i32 s70, s70, 24
    s_add_i32 s70, s70, s7
    s_ashr_i32 s70, s70, 3
    s_min_i32 s70, s70, 72
    s_max_i32 s70, s70, -72
    s_lshl3_add_u32 s10, s63, s3
    s_sub_i32 s10, s10, s67
    s_sub_i32 s10, s10, s70
    s_ashr_i32 s10, s10, 3
    s_min_i32 s65, s10, 16
    s_max_i32 s65, s65, 0
    s_bfm_b32 s61, s65, 0
    s_mul_i32 s61, s61, 0x10001
    s_lshr_b32 s61, s61, s64
    s_sub_i32 s65, s10, 16
    s_max_i32 s65, s65, 0
    s_min_i32 s65, s65, 16
    s_bfm_b32 s62, s65, 0
    s_mul_i32 s62, s62, 0x10001
    s_lshr_b32 s62, s62, s64
    v_xor_b32 v1, 0x94600, v1
    s_waitcnt vmcnt(3)
    s_bitcmp0_b32 s61, 8
    s_cbranch_scc1 L_p13
    s_waitcnt vmcnt(2)
    s_bitcmp0_b32 s62, 8
    s_cbranch_scc1 L_p13
    s_waitcnt vmcnt(1)
L_p13:
    buffer_load_dwordx4 v[160:163], v1, s[24:27], 0 offen offset:384 nt
    s_waitcnt vmcnt(3)
    s_bitcmp0_b32 s61, 9
    s_cbranch_scc1 L_p14
    s_waitcnt vmcnt(2)
    s_bitcmp0_b32 s62, 9
    s_cbranch_scc1 L_p14
    s_waitcnt vmcnt(1)
L_p14:
    buffer_load_dwordx4 v[164:167], v1, s[24:27], 0 offen offset:0 nt
    s_waitcnt vmcnt(3)
    s_bitcmp0_b32 s61, 10
    s_cbranch_scc1 L_p15
    s_waitcnt vmcnt(2)
    s_bitcmp0_b32 s62, 10
    s_cbranch_scc1 L_p15
    s_waitcnt vmcnt(1)
L_p15:
    buffer_load_dwordx4 v[168:171], v1, s[24:27], 0 offen offset:256 nt
    s_cmp_lg_u32 s22, 1
    s_cbranch_scc1 L_sh4
    s_lshl_b32 s10, s49, 8
    s_add_u32 s10, s10, 1
    v_mov_b32 v14, s10
    s_mov_b64 exec, 1
    buffer_store_dword v14, off, s[44:47], s19 sc1
    s_mov_b64 exec, -1
L_sh4:
    s_cmp_lg_u32 s22, 1
    s_cbranch_scc1 L_sh5
    v_and_b32 v12, 7, v0
    v_lshlrev_b32 v12, 9, v12
    s_andn2_b32 s10, s19, 0xe00
    s_mov_b64 exec, s[68:69]
    buffer_load_dword v13, v12, s[44:47], s10 offen sc1
    s_mov_b64 exec, -1
L_sh5:
    s_waitcnt vmcnt(3)
    s_bitcmp0_b32 s61, 11
    s_cbranch_scc1 L_p16
    s_waitcnt vmcnt(2)
    s_bitcmp0_b32 s62, 11
    s_cbranch_scc1 L_p16
    s_waitcnt vmcnt(1)
L_p16:
    buffer_load_dwordx4 v[172:175], v1, s[24:27], 0 offen offset:128 nt
    v_xor_b32 v1, 0x38600, v1
    s_waitcnt vmcnt(3)
    s_bitcmp0_b32 s61, 12
    s_cbranch_scc1 L_p17
    s_waitcnt vmcnt(2)
    s_bitcmp0_b32 s62, 12
    s_cbranch_scc1 L_p17
    s_waitcnt vmcnt(1)
L_p17:
    buffer_load_dwordx4 v[176:179], v1, s[24:27], 0 offen offset:0 nt
    s_waitcnt vmcnt(3)
    s_bitcmp0_b32 s61, 13
    s_cbranch_scc1 L_p18
    s_waitcnt vmcnt(2)
    s_bitcmp0_b32 s62, 13
    s_cbranch_scc1 L_p18
    s_waitcnt vmcnt(1)
L_p18:
    buffer_load_dwordx4 v[180:183], v1, s[24:27], 0 offen offset:384 nt
    s_waitcnt vmcnt(3)
    s_bitcmp0_b32 s61, 14
    s_cbranch_scc1 L_p19
    s_waitcnt vmcnt(2)
    s_bitcmp0_b32 s62, 14
    s_cbranch_scc1 L_p19
    s_waitcnt vmcnt(1)
L_p19:
    buffer_load_dwordx4 v[184:187], v1, s[24:27], 0 offen offset:128 nt
    s_waitcnt vmcnt(3)
    s_bitcmp0_b32 s61, 15
    s_cbranch_scc1 L_p20
    s_waitcnt vmcnt(2)
    s_bitcmp0_b32 s62, 15
    s_cbranch_scc1 L_p20
    s_waitcnt vmcnt(1)
L_p20:
    buffer_load_dwordx4 v[188:191], v1, s[24:27], 0 offen offset:256 nt
    s_cmp_lg_u32 s22, 1
    s_cbranch_scc1 L_sh6
    s_lshl_b32 s10, s8, 8
    s_add_u32 s10, s10, 0x3779b901
    v_cmp_eq_u32 vcc, s10, v13
    v_cmp_eq_u32 s[10:11], v14, v13
    v_subrev_u32 v14, 1, v14
    s_or_b64 vcc, vcc, s[10:11]
    v_lshrrev_b32 v12, 7, v12
    v_addc_co_u32 v14, vcc, 0, v14, vcc
    s_mov_b64 exec, s[68:69]
    buffer_store_dword v14, v12, s[44:47], s20 offen
    s_mov_b64 exec, -1
    s_nop 1
L_sh6:
    v_xor_b32 v1, 0x1bd200, v1
    s_waitcnt vmcnt(3)
    s_bitcmp0_b32 s61, 0
    s_cbranch_scc1 L_p21
    s_waitcnt vmcnt(2)
    s_bitcmp0_b32 s62, 0
    s_cbranch_scc1 L_p21
    s_waitcnt vmcnt(1)
L_p21:
    buffer_load_dwordx4 v[192:195], v1, s[24:27], 0 offen offset:128 nt
    s_waitcnt vmcnt(3)
    s_bitcmp0_b32 s61, 1
    s_cbranch_scc1 L_p22
    s_waitcnt vmcnt(2)
    s_bitcmp0_b32 s62, 1
    s_cbranch_scc1 L_p22
    s_waitcnt vmcnt(1)
L_p22:
    buffer_load_dwordx4 v[196:199], v1, s[24:27], 0 offen offset:256 nt
    s_waitcnt vmcnt(3)
    s_bitcmp0_b32 s61, 2
    s_cbranch_scc1 L_p23
    s_waitcnt vmcnt(2)
    s_bitcmp0_b32 s62, 2
    s_cbranch_scc1 L_p23
    s_waitcnt vmcnt(1)
L_p23:
    buffer_load_dwordx4 v[200:203], v1, s[24:27], 0 offen offset:0 nt
    s_lshl_b32 s71, s49, 8
    s_add_u32 s71, s71, 1
    v_mov_b32 v15, s71
    v_and_b32 v3, 63, v0
    v_lshlrev_b32 v3, 2, v3
    s_mov_b32 exec_lo, 0
    v_add_u32 v3, s21, v3
    s_mov_b64 exec, 1
    buffer_store_dword v15, off, s[44:47], s18
    s_mov_b64 exec, -1
    buffer_load_dword v3, v3, s[44:47], s16 offen
    s_waitcnt vmcnt(5)
    s_bitcmp0_b32 s61, 3
    s_cbranch_scc1 L_p24
    s_waitcnt vmcnt(4)
    s_bitcmp0_b32 s62, 3
    s_cbranch_scc1 L_p24
    s_waitcnt vmcnt(3)
L_p24:
    buffer_load_dwordx4 v[204:207], v1, s[24:27], 0 offen offset:384 nt
    v_xor_b32 v1, 0x38600, v1
    s_waitcnt vmcnt(5)
    s_bitcmp0_b32 s61, 4
    s_cbranch_scc1 L_p25
    s_waitcnt vmcnt(4)
    s_bitcmp0_b32 s62, 4
    s_cbranch_scc1 L_p25
    s_waitcnt vmcnt(3)
L_p25:
    buffer_load_dwordx4 v[208:211], v1, s[24:27], 0 offen offset:256 nt
    s_waitcnt vmcnt(5)
    s_bitcmp0_b32 s61, 5
    s_cbranch_scc1 L_p26
    s_waitcnt vmcnt(4)
    s_bitcmp0_b32 s62, 5
    s_cbranch_scc1 L_p26
    s_waitcnt vmcnt(1)
L_p26:
    buffer_load_dwordx4 v[212:215], v1, s[24:27], 0 offen offset:128 nt
    s_waitcnt vmcnt(5)
    s_bitcmp0_b32 s61, 6
    s_cbranch_scc1 L_p27
    s_waitcnt vmcnt(2)
    s_bitcmp0_b32 s62, 6
    s_cbranch_scc1 L_p27
    s_waitcnt vmcnt(1)
L_p27:
    buffer_load_dwordx4 v[216:219], v1, s[24:27], 0 offen offset:384 nt
    s_waitcnt vmcnt(3)
    s_bitcmp0_b32 s61, 7
    s_cbranch_scc1 L_p28
    s_waitcnt vmcnt(2)
    s_bitcmp0_b32 s62, 7
    s_cbranch_scc1 L_p28
    s_waitcnt vmcnt(1)
L_p28:
    buffer_load_dwordx4 v[220:223], v1, s[24:27], 0 offen offset:0 nt
    s_add_u32 s71, s71, 3
    v_sub_u32 v3, s71, v3
    v_cmp_gt_u32 vcc, 5, v3
    v_cmp_gt_u32 s[10:11], 4, v3
    s_bcnt1_i32_b32 s7, vcc_hi
    s_bcnt1_i32_b32 s11, s11
    s_mul_i32 s7, s7, 4294967290
    s_lshl3_add_u32 s7, s11, s7
    s_mul_i32 s7, s7, 16
    s_ashr_i32 s7, s7, 3
    s_bcnt1_i32_b32 s70, vcc_lo
    v_cmp_gt_u32 vcc, 3, v3
    s_bcnt1_i32_b32 s10, s10
    s_add_u32 s70, s70, s10
    s_bcnt1_i32_b32 s10, vcc_lo
    s_add_u32 s70, s70, s10
    s_sub_i32 s70, s70, 45
    s_mul_i32 s70, s70, 24
    s_add_i32 s70, s70, s7
    s_ashr_i32 s70, s70, 3
    s_min_i32 s70, s70, 72
    s_max_i32 s70, s70, -72
    s_lshl3_add_u32 s10, s63, s3
    s_sub_i32 s10, s10, s67
    s_sub_i32 s10, s10, s70
    s_ashr_i32 s10, s10, 3
    s_min_i32 s65, s10, 16
    s_max_i32 s65, s65, 0
    s_bfm_b32 s61, s65, 0
    s_mul_i32 s61, s61, 0x10001
    s_lshr_b32 s61, s61, s64
    s_sub_i32 s65, s10, 16
    s_max_i32 s65, s65, 0
    s_min_i32 s65, s65, 16
    s_bfm_b32 s62, s65, 0
    s_mul_i32 s62, s62, 0x10001
    s_lshr_b32 s62, s62, s64
    v_xor_b32 v1, 0x94600, v1
    s_waitcnt vmcnt(3)
    s_bitcmp0_b32 s61, 8
    s_cbranch_scc1 L_p29
    s_waitcnt vmcnt(2)
    s_bitcmp0_b32 s62, 8
    s_cbranch_scc1 L_p29
    s_waitcnt vmcnt(1)
L_p29:
    buffer_load_dwordx4 v[224:227], v1, s[24:27], 0 offen offset:256 nt
    s_waitcnt vmcnt(3)
    s_bitcmp0_b32 s61, 9
    s_cbranch_scc1 L_p30
    s_waitcnt vmcnt(2)
    s_bitcmp0_b32 s62, 9
    s_cbranch_scc1 L_p30
    s_waitcnt vmcnt(1)
L_p30:
    buffer_load_dwordx4 v[228:231], v1, s[24:27], 0 offen offset:128 nt
    s_mov_b32 s81, 0
L_qw:
    ds_read_b32 v39, v38 offset:47684
    ds_read_b128 v[16:19], v33 offset:47104
    ds_read_b128 v[20:23], v33 offset:47232
    ds_read_b128 v[24:27], v33 offset:47360
    ds_read_b128 v[28:31], v33 offset:47488
    s_waitcnt lgkmcnt(0)
    v_readfirstlane_b32 s86, v39
    s_nop 0
    s_cmp_lg_u32 s86, 0
    s_cbranch_scc1 L_qready
    s_add_u32 s81, s81, 1
    s_cmp_lt_u32 s81, 4000000
    s_sleep 1
    s_cbranch_scc1 L_qw
    s_branch L_qready
L_sync:
    v_mov_b32 v38, 0
    v_mov_b32 v39, 0
    ds_write_b64 v38, v[38:39] offset:47680
    ds_write_b64 v38, v[38:39] offset:47688
    ds_write_b64 v38, v[38:39] offset:47704
    s_waitcnt lgkmcnt(0)
    s_barrier
    s_load_dword s48, s[44:45], s89
    s_load_dword s23, s[90:91], s23
    s_xor_b32 s83, s89, 128
    s_load_dword s8, s[44:45], s83
    v_and_b32 v38, 1, v32
    v_lshlrev_b32 v38, 4, v38
    v_mov_b32 v39, 0xffff
    v_lshlrev_b32 v38, v38, v39
    v_lshrrev_b32 v39, 1, v32
    v_cmp_eq_u32 vcc, 0, v39
    s_nop 1
    v_cndmask_b32 v4, 0, v38, vcc
    v_cmp_eq_u32 vcc, 1, v39
    s_nop 1
    v_cndmask_b32 v5, 0, v38, vcc
    v_cmp_eq_u32 vcc, 2, v39
    s_nop 1
    v_cndmask_b32 v6, 0, v38, vcc
    v_cmp_eq_u32 vcc, 3, v39
    s_nop 1
    v_cndmask_b32 v7, 0, v38, vcc
    v_bfe_u32 v38, v0, 5, 1
    v_lshlrev_b32 v2, 2, v38
    v_bfe_u32 v38, v0, 3, 1
    v_lshl_add_u32 v2, v38, 1, v2
    v_bfe_u32 v38, v0, 4, 1
    v_add_u32 v2, v38, v2
    v_mul_u32_u24 v2, 896, v2
    v_add_u32 v2, v2, v33
    s_lshl_b32 s12, s3, 7
    s_cmp_eq_u32 s3, 7
    s_cselect_b32 s12, 0x8000000, s12
    v_add_u32 v2, s12, v2
    s_mov_b32 s12, s9
    s_and_b32 s51, s3, 3
    v_lshlrev_b32 v40, 4, v35
    v_lshrrev_b32 v39, 5, v35
    v_and_b32 v38, 31, v35
    v_lshlrev_b32 v38, 4, v38
    v_lshl_add_u32 v37, v39, 12, v38
    s_lshl_b32 s83, s4, 13
    s_add_u32 s83, s83, 786432
    s_lshl_b32 s84, s5, 9
    s_add_u32 s84, s84, s83
    s_lshl_b32 s85, s6, 12
    s_add_u32 s85, s85, s83
    v_mov_b32 v38, 0
    s_mul_i32 s86, s79, 131072
    s_lshl_b32 s87, s80, 11
    s_add_u32 s86, s86, s87
    v_lshlrev_b32 v31, 7, v35
    s_mov_b64 exec, 0x3fff
    buffer_load_dword v31, v31, s[44:47], s86 offen
    s_mov_b64 exec, -1
    s_mov_b64 exec, 0
    s_branch L_t0
L_r0:
    s_branch L_t1
L_r1:
    s_branch L_t2
L_r2:
    s_branch L_t3
L_r3:
    s_mov_b64 exec, -1
    s_waitcnt vmcnt(5)
    buffer_load_dwordx4 v[68:71], v1, s[24:27], 0 offen offset:384 nt
    s_waitcnt vmcnt(5)
    buffer_load_dwordx4 v[72:75], v1, s[24:27], 0 offen offset:128 nt
    s_waitcnt vmcnt(5)
    buffer_load_dwordx4 v[76:79], v1, s[24:27], 0 offen offset:256 nt
    v_xor_b32 v1, 0x38600, v1
    s_waitcnt vmcnt(5)
    buffer_load_dwordx4 v[80:83], v1, s[24:27], 0 offen offset:384 nt
    s_waitcnt vmcnt(3)
    buffer_load_dwordx4 v[84:87], v1, s[24:27], 0 offen offset:0 nt
    s_waitcnt vmcnt(3)
    buffer_load_dwordx4 v[88:91], v1, s[24:27], 0 offen offset:256 nt
    s_waitcnt vmcnt(3)
    buffer_load_dwordx4 v[92:95], v1, s[24:27], 0 offen offset:128 nt
    v_xor_b32 v1, 0x94600, v1
    s_waitcnt vmcnt(3)
L_t0:
    s_cbranch_execz L_r0
    buffer_load_dwordx4 v[96:99], v1, s[24:27], 0 offen offset:384 nt
    s_waitcnt vmcnt(3)
    buffer_load_dwordx4 v[100:103], v1, s[24:27], 0 offen offset:0 nt
    s_waitcnt vmcnt(3)
    buffer_load_dwordx4 v[104:107], v1, s[24:27], 0 offen offset:256 nt
    s_waitcnt vmcnt(3)
    buffer_load_dwordx4 v[108:111], v1, s[24:27], 0 offen offset:128 nt
    v_xor_b32 v1, 0x38600, v1
    s_waitcnt vmcnt(3)
    buffer_load_dwordx4 v[112:115], v1, s[24:27], 0 offen offset:0 nt
    s_mov_b32 s81, 0
L_ct:
    ds_read_b32 v39, v38 offset:47680
    ds_read_b128 v[200:203], v40 offset:0
    ds_read_b128 v[204:207], v40 offset:1088
    ds_read_b128 v[208:211], v40 offset:2176
    ds_read_b128 v[212:215], v40 offset:3264
    ds_read_b128 v[216:219], v40 offset:4352
    ds_read_b128 v[220:223], v40 offset:5440
    ds_read_b128 v[224:227], v40 offset:6528
    ds_read_b128 v[228:231], v40 offset:7616
    ds_read_b128 v[232:235], v40 offset:8704
    ds_read_b128 v[236:239], v40 offset:9792
    ds_read_b128 v[240:243], v40 offset:10880
    ds_read_b128 v[244:247], v40 offset:11968
    ds_read_b128 v[248:251], v40 offset:13056
    ds_read_b128 v[252:255], v40 offset:14144
    s_waitcnt lgkmcnt(0)
    v_readfirstlane_b32 s86, v39
    s_nop 0
    s_cmp_ge_u32 s86, 7
    s_cbranch_scc1 L_ct_ok
    s_add_u32 s81, s81, 1
    s_cmp_lt_u32 s81, 1000000
    s_sleep 1
    s_cbranch_scc1 L_ct
L_ct_ok:
    s_add_u32 s49, s48, 0x9e3779b9
    s_mov_b32 s86, 0x07060503
    s_mov_b32 s87, 0x07060502
    s_mov_b32 s88, 0x07060501
    v_add_f32 v200, v200, v204
    v_add_f32 v201, v201, v205
    v_add_f32 v202, v202, v206
    v_add_f32 v203, v203, v207
    v_add_f32 v208, v208, v212
    v_add_f32 v209, v209, v213
    v_add_f32 v210, v210, v214
    v_add_f32 v211, v211, v215
    v_add_f32 v216, v216, v220
    v_add_f32 v217, v217, v221
    v_add_f32 v218, v218, v222
    v_add_f32 v219, v219, v223
    v_add_f32 v224, v224, v228
    v_add_f32 v225, v225, v229
    v_add_f32 v226, v226, v230
    v_add_f32 v227, v227, v231
    v_add_f32 v232, v232, v236
    v_add_f32 v233, v233, v237
    v_add_f32 v234, v234, v238
    v_add_f32 v235, v235, v239
    v_add_f32 v240, v240, v244
    v_add_f32 v241, v241, v245
    v_add_f32 v242, v242, v246
    v_add_f32 v243, v243, v247
    v_add_f32 v248, v248, v252
    v_add_f32 v249, v249, v253
    v_add_f32 v250, v250, v254
    v_add_f32 v251, v251, v255
    v_add_f32 v200, v200, v208
    v_add_f32 v201, v201, v209
    v_add_f32 v202, v202, v210
    v_add_f32 v203, v203, v211
    v_add_f32 v216, v216, v224
    v_add_f32 v217, v217, v225
    v_add_f32 v218, v218, v226
    v_add_f32 v219, v219, v227
    v_add_f32 v232, v232, v240
    v_add_f32 v233, v233, v241
    v_add_f32 v234, v234, v242
    v_add_f32 v235, v235, v243
    v_add_f32 v200, v200, v216
    v_add_f32 v201, v201, v217
    v_add_f32 v202, v202, v218
    v_add_f32 v203, v203, v219
    v_add_f32 v232, v232, v248
    v_add_f32 v233, v233, v249
    v_add_f32 v234, v234, v250
    v_add_f32 v235, v235, v251
    v_add_f32 v200, v200, v232
    v_add_f32 v201, v201, v233
    v_add_f32 v202, v202, v234
    v_add_f32 v203, v203, v235
    v_perm_b32 v48, v200, v203, s86
    v_perm_b32 v49, v201, v203, s87
    v_perm_b32 v50, v202, v203, s88
    v_mov_b32 v51, s49
    buffer_store_dwordx4 v[48:51], v37, s[44:47], s84 offen sc1
    s_waitcnt vmcnt(3)
    buffer_load_dwordx4 v[116:119], v1, s[24:27], 0 offen offset:384 nt
    s_waitcnt vmcnt(3)
    buffer_load_dwordx4 v[120:123], v1, s[24:27], 0 offen offset:128 nt
    s_waitcnt vmcnt(3)
    buffer_load_dwordx4 v[124:127], v1, s[24:27], 0 offen offset:256 nt
    v_xor_b32 v1, 0x58a00, v1
    s_waitcnt vmcnt(3)
    buffer_load_dwordx4 v[128:131], v1, s[24:27], 0 offen offset:0 nt
    s_waitcnt vmcnt(3)
    buffer_load_dwordx4 v[132:135], v1, s[24:27], 0 offen offset:384 nt
    s_waitcnt vmcnt(3)
    buffer_load_dwordx4 v[136:139], v1, s[24:27], 0 offen offset:128 nt
    s_waitcnt vmcnt(3)
    buffer_load_dwordx4 v[140:143], v1, s[24:27], 0 offen offset:256 nt
    v_xor_b32 v1, 0x38600, v1
    s_waitcnt vmcnt(3)
    buffer_load_dwordx4 v[144:147], v1, s[24:27], 0 offen offset:384 nt
    s_waitcnt vmcnt(3)
    buffer_load_dwordx4 v[148:151], v1, s[24:27], 0 offen offset:0 nt
    s_waitcnt vmcnt(3)
    buffer_load_dwordx4 v[152:155], v1, s[24:27], 0 offen offset:256 nt
    s_waitcnt vmcnt(3)
    buffer_load_dwordx4 v[156:159], v1, s[24:27], 0 offen offset:128 nt
    v_xor_b32 v1, 0x94600, v1
    s_waitcnt vmcnt(3)
    buffer_load_dwordx4 v[160:163], v1, s[24:27], 0 offen offset:384 nt
    s_waitcnt vmcnt(3)
    buffer_load_dwordx4 v[164:167], v1, s[24:27], 0 offen offset:0 nt
    s_waitcnt vmcnt(3)
    buffer_load_dwordx4 v[168:171], v1, s[24:27], 0 offen offset:256 nt
    s_waitcnt vmcnt(3)
    buffer_load_dwordx4 v[172:175], v1, s[24:27], 0 offen offset:128 nt
    v_xor_b32 v1, 0x38600, v1
    s_waitcnt vmcnt(3)
    buffer_load_dwordx4 v[176:179], v1, s[24:27], 0 offen offset:0 nt
    s_waitcnt vmcnt(3)
    buffer_load_dwordx4 v[180:183], v1, s[24:27], 0 offen offset:384 nt
    s_waitcnt vmcnt(3)
    buffer_load_dwordx4 v[184:187], v1, s[24:27], 0 offen offset:128 nt
    s_waitcnt vmcnt(3)
    buffer_load_dwordx4 v[188:191], v1, s[24:27], 0 offen offset:256 nt
    v_xor_b32 v1, 0x1bd200, v1
    s_waitcnt vmcnt(3)
    buffer_load_dwordx4 v[192:195], v1, s[24:27], 0 offen offset:128 nt
    s_waitcnt vmcnt(3)
    buffer_load_dwordx4 v[196:199], v1, s[24:27], 0 offen offset:256 nt
    s_waitcnt vmcnt(3)
    buffer_load_dwordx4 v[200:203], v1, s[24:27], 0 offen offset:0 nt
    s_waitcnt vmcnt(3)
    buffer_load_dwordx4 v[204:207], v1, s[24:27], 0 offen offset:384 nt
    s_waitcnt vmcnt(3)
    buffer_load_dwordx4 v[240:243], v40, s[44:47], s85 offen offset:0 sc1
    s_waitcnt vmcnt(3)
    buffer_load_dwordx4 v[244:247], v40, s[44:47], s85 offen offset:1024 sc1
    s_waitcnt vmcnt(3)
    buffer_load_dwordx4 v[248:251], v40, s[44:47], s85 offen offset:2048 sc1
    s_waitcnt vmcnt(3)
    buffer_load_dwordx4 v[252:255], v40, s[44:47], s85 offen offset:3072 sc1
    v_xor_b32 v1, 0x38600, v1
    s_waitcnt vmcnt(3)
    buffer_load_dwordx4 v[208:211], v1, s[24:27], 0 offen offset:256 nt
    s_waitcnt vmcnt(3)
    buffer_load_dwordx4 v[212:215], v1, s[24:27], 0 offen offset:128 nt
    s_waitcnt vmcnt(3)
    buffer_load_dwordx4 v[216:219], v1, s[24:27], 0 offen offset:384 nt
    s_waitcnt vmcnt(3)
    buffer_load_dwordx4 v[220:223], v1, s[24:27], 0 offen offset:0 nt
    s_mov_b32 s81, 0
L_qchk:
    v_xor_b32 v243, s49, v243
    v_xor_b32 v247, s49, v247
    v_xor_b32 v251, s49, v251
    v_xor_b32 v255, s49, v255
    v_or3_b32 v38, v243, v247, v251
    v_or_b32 v38, v38, v255
    v_cmp_ne_u32 vcc, 0, v38
    s_nop 1
    s_cmp_eq_u64 vcc, 0
    s_cbranch_scc1 L_qok
    s_add_u32 s81, s81, 1
    s_cmp_ge_u32 s81, 100000
    s_cbranch_scc1 L_qok
    buffer_load_dwordx4 v[240:243], v40, s[44:47], s85 offen offset:0 sc1
    buffer_load_dwordx4 v[244:247], v40, s[44:47], s85 offen offset:1024 sc1
    buffer_load_dwordx4 v[248:251], v40, s[44:47], s85 offen offset:2048 sc1
    buffer_load_dwordx4 v[252:255], v40, s[44:47], s85 offen offset:3072 sc1
    s_waitcnt vmcnt(0)
    s_branch L_qchk
L_qok:
    s_mov_b32 s86, 0x04000c0c
    s_mov_b32 s87, 0x0706000c
    v_perm_b32 v243, v240, v241, s86
    v_perm_b32 v247, v244, v245, s86
    v_perm_b32 v251, v248, v249, s86
    v_perm_b32 v255, v252, v253, s86
    v_perm_b32 v243, v243, v242, s87
    v_perm_b32 v247, v247, v246, s87
    v_perm_b32 v251, v251, v250, s87
    v_perm_b32 v255, v255, v254, s87
    v_add_f32 v240, v240, v244
    v_add_f32 v241, v241, v245
    v_add_f32 v242, v242, v246
    v_add_f32 v243, v243, v247
    v_add_f32 v248, v248, v252
    v_add_f32 v249, v249, v253
    v_add_f32 v250, v250, v254
    v_add_f32 v251, v251, v255
    v_add_f32 v240, v240, v248
    v_add_f32 v241, v241, v249
    v_add_f32 v242, v242, v250
    v_add_f32 v243, v243, v251
    v_cvt_pk_bf16_f32 v52, v240, v241
    v_cvt_pk_bf16_f32 v53, v242, v243
    v_lshlrev_b32 v38, 3, v35
    ds_write_b64 v38, v[52:53] offset:47104
    v_mov_b32 v38, 0
    v_mov_b32 v39, 1
    s_waitcnt lgkmcnt(0)
    ds_write_b32 v38, v39 offset:47684
    ds_read_b128 v[16:19], v33 offset:47104
    ds_read_b128 v[20:23], v33 offset:47232
    ds_read_b128 v[24:27], v33 offset:47360
    ds_read_b128 v[28:31], v33 offset:47488
    v_xor_b32 v1, 0x94600, v1
    s_waitcnt vmcnt(3)
    buffer_load_dwordx4 v[224:227], v1, s[24:27], 0 offen offset:256 nt
    s_waitcnt vmcnt(3)
    buffer_load_dwordx4 v[228:231], v1, s[24:27], 0 offen offset:128 nt
    s_waitcnt lgkmcnt(0)
L_qready:
    v_mov_b32 v32, 0
    v_dot2c_f32_bf16 v32, v64, v16
    v_dot2c_f32_bf16 v32, v65, v17
    v_dot2c_f32_bf16 v32, v66, v18
    v_dot2c_f32_bf16 v32, v67, v19
    v_dot2c_f32_bf16 v32, v68, v28
    v_dot2c_f32_bf16 v32, v69, v29
    v_dot2c_f32_bf16 v32, v70, v30
    v_dot2c_f32_bf16 v32, v71, v31
    v_dot2c_f32_bf16 v32, v72, v20
    v_dot2c_f32_bf16 v32, v73, v21
    v_dot2c_f32_bf16 v32, v74, v22
    v_dot2c_f32_bf16 v32, v75, v23
    v_dot2c_f32_bf16 v32, v76, v24
    v_dot2c_f32_bf16 v32, v77, v25
    v_dot2c_f32_bf16 v32, v78, v26
    v_dot2c_f32_bf16 v32, v79, v27
    v_mov_b32 v33, 0
    v_dot2c_f32_bf16 v33, v80, v28
    v_dot2c_f32_bf16 v33, v81, v29
    v_dot2c_f32_bf16 v33, v82, v30
    v_dot2c_f32_bf16 v33, v83, v31
    v_dot2c_f32_bf16 v33, v84, v16
    v_dot2c_f32_bf16 v33, v85, v17
    v_dot2c_f32_bf16 v33, v86, v18
    v_dot2c_f32_bf16 v33, v87, v19
    v_dot2c_f32_bf16 v33, v88, v24
    v_dot2c_f32_bf16 v33, v89, v25
    v_dot2c_f32_bf16 v33, v90, v26
    v_dot2c_f32_bf16 v33, v91, v27
    v_dot2c_f32_bf16 v33, v92, v20
    v_dot2c_f32_bf16 v33, v93, v21
    v_dot2c_f32_bf16 v33, v94, v22
    v_dot2c_f32_bf16 v33, v95, v23
    v_mov_b32 v34, 0
    v_dot2c_f32_bf16 v34, v96, v28
    v_dot2c_f32_bf16 v34, v97, v29
    v_dot2c_f32_bf16 v34, v98, v30
    v_dot2c_f32_bf16 v34, v99, v31
    v_dot2c_f32_bf16 v34, v100, v16
    v_dot2c_f32_bf16 v34, v101, v17
    v_dot2c_f32_bf16 v34, v102, v18
    v_dot2c_f32_bf16 v34, v103, v19
    v_dot2c_f32_bf16 v34, v104, v24
    v_dot2c_f32_bf16 v34, v105, v25
    v_dot2c_f32_bf16 v34, v106, v26
    v_dot2c_f32_bf16 v34, v107, v27
    v_dot2c_f32_bf16 v34, v108, v20
    v_dot2c_f32_bf16 v34, v109, v21
    v_dot2c_f32_bf16 v34, v110, v22
    v_dot2c_f32_bf16 v34, v111, v23
    v_mov_b32 v35, 0
    v_dot2c_f32_bf16 v35, v112, v16
    v_dot2c_f32_bf16 v35, v113, v17
    v_dot2c_f32_bf16 v35, v114, v18
    v_dot2c_f32_bf16 v35, v115, v19
    v_dot2c_f32_bf16 v35, v116, v28
    v_dot2c_f32_bf16 v35, v117, v29
    v_dot2c_f32_bf16 v35, v118, v30
    v_dot2c_f32_bf16 v35, v119, v31
    buffer_load_dwordx4 v[64:67], v2, s[40:43], s12 offen
    s_add_u32 s12, s12, 7168
    v_dot2c_f32_bf16 v35, v120, v20
    v_dot2c_f32_bf16 v35, v121, v21
    v_dot2c_f32_bf16 v35, v122, v22
    v_dot2c_f32_bf16 v35, v123, v23
    v_dot2c_f32_bf16 v35, v124, v24
    v_dot2c_f32_bf16 v35, v125, v25
    v_dot2c_f32_bf16 v35, v126, v26
    v_dot2c_f32_bf16 v35, v127, v27
    v_add_f32_dpp v32, v32, v32 quad_perm:[1,0,3,2] row_mask:0xf bank_mask:0xf
    v_add_f32_dpp v33, v33, v33 quad_perm:[1,0,3,2] row_mask:0xf bank_mask:0xf
    v_add_f32_dpp v34, v34, v34 quad_perm:[1,0,3,2] row_mask:0xf bank_mask:0xf
    v_add_f32_dpp v35, v35, v35 quad_perm:[1,0,3,2] row_mask:0xf bank_mask:0xf
    v_add_f32_dpp v32, v32, v32 quad_perm:[2,3,0,1] row_mask:0xf bank_mask:0xf
    v_add_f32_dpp v33, v33, v33 quad_perm:[2,3,0,1] row_mask:0xf bank_mask:0xf
    v_add_f32_dpp v34, v34, v34 quad_perm:[2,3,0,1] row_mask:0xf bank_mask:0xf
    v_add_f32_dpp v35, v35, v35 quad_perm:[2,3,0,1] row_mask:0xf bank_mask:0xf
    v_add_f32_dpp v32, v32, v32 row_half_mirror row_mask:0xf bank_mask:0xf
    v_add_f32_dpp v33, v33, v33 row_half_mirror row_mask:0xf bank_mask:0xf
    v_add_f32_dpp v34, v34, v34 row_half_mirror row_mask:0xf bank_mask:0xf
    v_add_f32_dpp v35, v35, v35 row_half_mirror row_mask:0xf bank_mask:0xf
    v_mov_b32 v36, 0
    v_dot2c_f32_bf16 v36, v128, v16
    v_dot2c_f32_bf16 v36, v129, v17
    v_dot2c_f32_bf16 v36, v130, v18
    v_dot2c_f32_bf16 v36, v131, v19
    v_dot2c_f32_bf16 v36, v132, v28
    v_dot2c_f32_bf16 v36, v133, v29
    v_dot2c_f32_bf16 v36, v134, v30
    v_dot2c_f32_bf16 v36, v135, v31
    v_dot2c_f32_bf16 v36, v136, v20
    v_dot2c_f32_bf16 v36, v137, v21
    v_dot2c_f32_bf16 v36, v138, v22
    v_dot2c_f32_bf16 v36, v139, v23
    v_dot2c_f32_bf16 v36, v140, v24
    v_dot2c_f32_bf16 v36, v141, v25
    v_dot2c_f32_bf16 v36, v142, v26
    v_dot2c_f32_bf16 v36, v143, v27
    v_mov_b32 v37, 0
    v_dot2c_f32_bf16 v37, v144, v28
    v_dot2c_f32_bf16 v37, v145, v29
    v_dot2c_f32_bf16 v37, v146, v30
    v_dot2c_f32_bf16 v37, v147, v31
    v_dot2c_f32_bf16 v37, v148, v16
    v_dot2c_f32_bf16 v37, v149, v17
    v_dot2c_f32_bf16 v37, v150, v18
    v_dot2c_f32_bf16 v37, v151, v19
    v_dot2c_f32_bf16 v37, v152, v24
    v_dot2c_f32_bf16 v37, v153, v25
    v_dot2c_f32_bf16 v37, v154, v26
    v_dot2c_f32_bf16 v37, v155, v27
    v_dot2c_f32_bf16 v37, v156, v20
    v_dot2c_f32_bf16 v37, v157, v21
    v_dot2c_f32_bf16 v37, v158, v22
    v_dot2c_f32_bf16 v37, v159, v23
    v_mov_b32 v38, 0
    v_dot2c_f32_bf16 v38, v160, v28
    v_dot2c_f32_bf16 v38, v161, v29
    v_dot2c_f32_bf16 v38, v162, v30
    v_dot2c_f32_bf16 v38, v163, v31
    v_dot2c_f32_bf16 v38, v164, v16
    v_dot2c_f32_bf16 v38, v165, v17
    v_dot2c_f32_bf16 v38, v166, v18
    v_dot2c_f32_bf16 v38, v167, v19
    s_waitcnt vmcnt(4)
    s_bitcmp0_b32 s61, 10
    s_cbranch_scc1 L_p31
    s_waitcnt vmcnt(3)
    s_bitcmp0_b32 s62, 10
    s_cbranch_scc1 L_p31
    s_waitcnt vmcnt(2)
L_p31:
    buffer_load_dwordx4 v[232:235], v1, s[24:27], 0 offen offset:384 nt
    s_cmp_lg_u32 s22, 2
    s_cbranch_scc1 L_sh7
    s_lshl_b32 s10, s49, 8
    s_add_u32 s10, s10, 2
    v_mov_b32 v14, s10
    s_mov_b64 exec, 1
    buffer_store_dword v14, off, s[44:47], s19 sc1
    s_mov_b64 exec, -1
L_sh7:
    s_cmp_lg_u32 s22, 2
    s_cbranch_scc1 L_sh8
    v_and_b32 v12, 7, v0
    v_lshlrev_b32 v12, 9, v12
    s_andn2_b32 s10, s19, 0xe00
    s_mov_b64 exec, s[68:69]
    buffer_load_dword v13, v12, s[44:47], s10 offen sc1
    s_mov_b64 exec, -1
L_sh8:
    v_dot2c_f32_bf16 v38, v168, v24
    v_dot2c_f32_bf16 v38, v169, v25
    v_dot2c_f32_bf16 v38, v170, v26
    v_dot2c_f32_bf16 v38, v171, v27
    v_dot2c_f32_bf16 v38, v172, v20
    v_dot2c_f32_bf16 v38, v173, v21
    v_dot2c_f32_bf16 v38, v174, v22
    v_dot2c_f32_bf16 v38, v175, v23
    v_mov_b32 v39, 0
    v_dot2c_f32_bf16 v39, v176, v16
    v_dot2c_f32_bf16 v39, v177, v17
    v_dot2c_f32_bf16 v39, v178, v18
    v_dot2c_f32_bf16 v39, v179, v19
    v_dot2c_f32_bf16 v39, v180, v28
    v_dot2c_f32_bf16 v39, v181, v29
    v_dot2c_f32_bf16 v39, v182, v30
    v_dot2c_f32_bf16 v39, v183, v31
    v_dot2c_f32_bf16 v39, v184, v20
    v_dot2c_f32_bf16 v39, v185, v21
    v_dot2c_f32_bf16 v39, v186, v22
    v_dot2c_f32_bf16 v39, v187, v23
    v_dot2c_f32_bf16 v39, v188, v24
    v_dot2c_f32_bf16 v39, v189, v25
    v_dot2c_f32_bf16 v39, v190, v26
    v_dot2c_f32_bf16 v39, v191, v27
    v_add_f32_dpp v36, v36, v36 quad_perm:[1,0,3,2] row_mask:0xf bank_mask:0xf
    v_add_f32_dpp v37, v37, v37 quad_perm:[1,0,3,2] row_mask:0xf bank_mask:0xf
    v_add_f32_dpp v38, v38, v38 quad_perm:[1,0,3,2] row_mask:0xf bank_mask:0xf
    v_add_f32_dpp v39, v39, v39 quad_perm:[1,0,3,2] row_mask:0xf bank_mask:0xf
    v_add_f32_dpp v36, v36, v36 quad_perm:[2,3,0,1] row_mask:0xf bank_mask:0xf
    v_add_f32_dpp v37, v37, v37 quad_perm:[2,3,0,1] row_mask:0xf bank_mask:0xf
    v_add_f32_dpp v38, v38, v38 quad_perm:[2,3,0,1] row_mask:0xf bank_mask:0xf
    v_add_f32_dpp v39, v39, v39 quad_perm:[2,3,0,1] row_mask:0xf bank_mask:0xf
    v_add_f32_dpp v36, v36, v36 row_half_mirror row_mask:0xf bank_mask:0xf
    v_add_f32_dpp v37, v37, v37 row_half_mirror row_mask:0xf bank_mask:0xf
    v_add_f32_dpp v38, v38, v38 row_half_mirror row_mask:0xf bank_mask:0xf
    v_add_f32_dpp v39, v39, v39 row_half_mirror row_mask:0xf bank_mask:0xf
    v_mov_b32 v40, 0
    v_dot2c_f32_bf16 v40, v192, v20
    v_dot2c_f32_bf16 v40, v193, v21
    v_dot2c_f32_bf16 v40, v194, v22
    v_dot2c_f32_bf16 v40, v195, v23
    v_dot2c_f32_bf16 v40, v196, v24
    v_dot2c_f32_bf16 v40, v197, v25
    v_dot2c_f32_bf16 v40, v198, v26
    v_dot2c_f32_bf16 v40, v199, v27
    v_dot2c_f32_bf16 v40, v200, v16
    v_dot2c_f32_bf16 v40, v201, v17
    v_dot2c_f32_bf16 v40, v202, v18
    v_dot2c_f32_bf16 v40, v203, v19
    v_dot2c_f32_bf16 v40, v204, v28
    v_dot2c_f32_bf16 v40, v205, v29
    v_dot2c_f32_bf16 v40, v206, v30
    v_dot2c_f32_bf16 v40, v207, v31
    v_mov_b32 v41, 0
    v_dot2c_f32_bf16 v41, v208, v24
    v_dot2c_f32_bf16 v41, v209, v25
    v_dot2c_f32_bf16 v41, v210, v26
    v_dot2c_f32_bf16 v41, v211, v27
    v_dot2c_f32_bf16 v41, v212, v20
    v_dot2c_f32_bf16 v41, v213, v21
    v_dot2c_f32_bf16 v41, v214, v22
    v_dot2c_f32_bf16 v41, v215, v23
    s_waitcnt vmcnt(4)
    s_bitcmp0_b32 s61, 11
    s_cbranch_scc1 L_p32
    s_waitcnt vmcnt(3)
    s_bitcmp0_b32 s62, 11
    s_cbranch_scc1 L_p32
    s_waitcnt vmcnt(2)
L_p32:
    buffer_load_dwordx4 v[236:239], v1, s[24:27], 0 offen offset:0 nt
    v_dot2c_f32_bf16 v41, v216, v28
    v_dot2c_f32_bf16 v41, v217, v29
    v_dot2c_f32_bf16 v41, v218, v30
    v_dot2c_f32_bf16 v41, v219, v31
    v_dot2c_f32_bf16 v41, v220, v16
    v_dot2c_f32_bf16 v41, v221, v17
    v_dot2c_f32_bf16 v41, v222, v18
    v_dot2c_f32_bf16 v41, v223, v19
    buffer_load_dwordx4 v[68:71], v2, s[40:43], s12 offen
    s_add_u32 s12, s12, 7168
    v_xor_b32 v1, 0x38600, v1
    s_waitcnt vmcnt(5)
    s_bitcmp0_b32 s61, 12
    s_cbranch_scc1 L_p33
    s_waitcnt vmcnt(4)
    s_bitcmp0_b32 s62, 12
    s_cbranch_scc1 L_p33
    s_waitcnt vmcnt(2)
L_p33:
    buffer_load_dwordx4 v[240:243], v1, s[24:27], 0 offen offset:128 nt
    v_mov_b32 v42, 0
    v_dot2c_f32_bf16 v42, v224, v24
    v_dot2c_f32_bf16 v42, v225, v25
    v_dot2c_f32_bf16 v42, v226, v26
    v_dot2c_f32_bf16 v42, v227, v27
    s_waitcnt vmcnt(5)
    s_bitcmp0_b32 s61, 13
    s_cbranch_scc1 L_p34
    s_waitcnt vmcnt(3)
    s_bitcmp0_b32 s62, 13
    s_cbranch_scc1 L_p34
    s_waitcnt vmcnt(2)
L_p34:
    buffer_load_dwordx4 v[244:247], v1, s[24:27], 0 offen offset:256 nt
    v_dot2c_f32_bf16 v42, v228, v20
    v_dot2c_f32_bf16 v42, v229, v21
    v_dot2c_f32_bf16 v42, v230, v22
    v_dot2c_f32_bf16 v42, v231, v23
    buffer_load_dwordx4 v[72:75], v2, s[40:43], s12 offen
    s_add_u32 s12, s12, 7168
    s_waitcnt vmcnt(5)
    s_bitcmp0_b32 s61, 14
    s_cbranch_scc1 L_p35
    s_waitcnt vmcnt(4)
    s_bitcmp0_b32 s62, 14
    s_cbranch_scc1 L_p35
    s_waitcnt vmcnt(2)
L_p35:
    buffer_load_dwordx4 v[248:251], v1, s[24:27], 0 offen offset:0 nt
    v_dot2c_f32_bf16 v42, v232, v28
    v_dot2c_f32_bf16 v42, v233, v29
    v_dot2c_f32_bf16 v42, v234, v30
    v_dot2c_f32_bf16 v42, v235, v31
    s_waitcnt vmcnt(5)
    s_bitcmp0_b32 s61, 15
    s_cbranch_scc1 L_p36
    s_waitcnt vmcnt(3)
    s_bitcmp0_b32 s62, 15
    s_cbranch_scc1 L_p36
    s_waitcnt vmcnt(2)
L_p36:
    buffer_load_dwordx4 v[252:255], v1, s[24:27], 0 offen offset:384 nt
    s_cmp_lg_u32 s22, 2
    s_cbranch_scc1 L_sh9
    s_lshl_b32 s10, s8, 8
    s_add_u32 s10, s10, 0x3779b902
    v_cmp_eq_u32 vcc, s10, v13
    v_cmp_eq_u32 s[10:11], v14, v13
    v_subrev_u32 v14, 2, v14
    s_or_b64 vcc, vcc, s[10:11]
    v_lshrrev_b32 v12, 7, v12
    v_addc_co_u32 v14, vcc, 0, v14, vcc
    s_mov_b64 exec, s[68:69]
    buffer_store_dword v14, v12, s[44:47], s20 offen
    s_mov_b64 exec, -1
    s_nop 1
L_sh9:
    v_dot2c_f32_bf16 v42, v236, v16
    v_dot2c_f32_bf16 v42, v237, v17
    v_dot2c_f32_bf16 v42, v238, v18
    v_dot2c_f32_bf16 v42, v239, v19
    buffer_load_dwordx4 v[76:79], v2, s[40:43], s12 offen
    s_add_u32 s12, s12, 7168
    v_xor_b32 v1, 0x58a00, v1
    s_waitcnt vmcnt(5)
    s_bitcmp0_b32 s61, 0
    s_cbranch_scc1 L_p37
    s_waitcnt vmcnt(4)
    s_bitcmp0_b32 s62, 0
    s_cbranch_scc1 L_p37
    s_waitcnt vmcnt(2)
L_p37:
    buffer_load_dwordx4 v[192:195], v1, s[24:27], 0 offen offset:128 nt
    v_mov_b32 v43, 0
    v_dot2c_f32_bf16 v43, v240, v20
    v_dot2c_f32_bf16 v43, v241, v21
    v_dot2c_f32_bf16 v43, v242, v22
    v_dot2c_f32_bf16 v43, v243, v23
    s_waitcnt vmcnt(5)
    s_bitcmp0_b32 s61, 1
    s_cbranch_scc1 L_p38
    s_waitcnt vmcnt(3)
    s_bitcmp0_b32 s62, 1
    s_cbranch_scc1 L_p38
    s_waitcnt vmcnt(2)
L_p38:
    buffer_load_dwordx4 v[196:199], v1, s[24:27], 0 offen offset:256 nt
    v_dot2c_f32_bf16 v43, v244, v24
    v_dot2c_f32_bf16 v43, v245, v25
    v_dot2c_f32_bf16 v43, v246, v26
    v_dot2c_f32_bf16 v43, v247, v27
    s_waitcnt vmcnt(4)
    s_bitcmp0_b32 s61, 2
    s_cbranch_scc1 L_p39
    s_waitcnt vmcnt(3)
    s_bitcmp0_b32 s62, 2
    s_cbranch_scc1 L_p39
    s_waitcnt vmcnt(1)
L_p39:
    buffer_load_dwordx4 v[200:203], v1, s[24:27], 0 offen offset:0 nt
    s_lshl_b32 s71, s49, 8
    s_add_u32 s71, s71, 2
    v_mov_b32 v15, s71
    v_and_b32 v3, 63, v0
    v_lshlrev_b32 v3, 2, v3
    s_mov_b32 exec_lo, 0
    v_add_u32 v3, s21, v3
    s_mov_b64 exec, 1
    buffer_store_dword v15, off, s[44:47], s18
    s_mov_b64 exec, -1
    buffer_load_dword v3, v3, s[44:47], s16 offen
    v_dot2c_f32_bf16 v43, v248, v16
    v_dot2c_f32_bf16 v43, v249, v17
    v_dot2c_f32_bf16 v43, v250, v18
    v_dot2c_f32_bf16 v43, v251, v19
    buffer_load_dwordx4 v[80:83], v2, s[40:43], s12 offen
    s_add_u32 s12, s12, 7168
    s_waitcnt vmcnt(7)
    s_bitcmp0_b32 s61, 3
    s_cbranch_scc1 L_p40
    s_waitcnt vmcnt(5)
    s_bitcmp0_b32 s62, 3
    s_cbranch_scc1 L_p40
    s_waitcnt vmcnt(4)
L_p40:
    buffer_load_dwordx4 v[204:207], v1, s[24:27], 0 offen offset:384 nt
    v_dot2c_f32_bf16 v43, v252, v28
    v_dot2c_f32_bf16 v43, v253, v29
    v_dot2c_f32_bf16 v43, v254, v30
    v_dot2c_f32_bf16 v43, v255, v31
    v_add_f32_dpp v40, v40, v40 quad_perm:[1,0,3,2] row_mask:0xf bank_mask:0xf
    v_add_f32_dpp v41, v41, v41 quad_perm:[1,0,3,2] row_mask:0xf bank_mask:0xf
    v_add_f32_dpp v42, v42, v42 quad_perm:[1,0,3,2] row_mask:0xf bank_mask:0xf
    v_add_f32_dpp v43, v43, v43 quad_perm:[1,0,3,2] row_mask:0xf bank_mask:0xf
    v_add_f32_dpp v40, v40, v40 quad_perm:[2,3,0,1] row_mask:0xf bank_mask:0xf
    v_add_f32_dpp v41, v41, v41 quad_perm:[2,3,0,1] row_mask:0xf bank_mask:0xf
    v_add_f32_dpp v42, v42, v42 quad_perm:[2,3,0,1] row_mask:0xf bank_mask:0xf
    v_add_f32_dpp v43, v43, v43 quad_perm:[2,3,0,1] row_mask:0xf bank_mask:0xf
    v_add_f32_dpp v40, v40, v40 row_half_mirror row_mask:0xf bank_mask:0xf
    v_add_f32_dpp v41, v41, v41 row_half_mirror row_mask:0xf bank_mask:0xf
    v_add_f32_dpp v42, v42, v42 row_half_mirror row_mask:0xf bank_mask:0xf
    v_add_f32_dpp v43, v43, v43 row_half_mirror row_mask:0xf bank_mask:0xf
    v_xor_b32 v1, 0x38600, v1
    s_waitcnt vmcnt(6)
    s_bitcmp0_b32 s61, 4
    s_cbranch_scc1 L_p41
    s_waitcnt vmcnt(5)
    s_bitcmp0_b32 s62, 4
    s_cbranch_scc1 L_p41
    s_waitcnt vmcnt(4)
L_p41:
    buffer_load_dwordx4 v[208:211], v1, s[24:27], 0 offen offset:256 nt
    v_mov_b32 v44, 0
    v_dot2c_f32_bf16 v44, v192, v20
    v_dot2c_f32_bf16 v44, v193, v21
    v_dot2c_f32_bf16 v44, v194, v22
    v_dot2c_f32_bf16 v44, v195, v23
    buffer_load_dwordx4 v[84:87], v2, s[40:43], s12 offen
    s_add_u32 s12, s12, 7168
    s_waitcnt vmcnt(7)
    s_bitcmp0_b32 s61, 5
    s_cbranch_scc1 L_p42
    s_waitcnt vmcnt(6)
    s_bitcmp0_b32 s62, 5
    s_cbranch_scc1 L_p42
    s_waitcnt vmcnt(2)
L_p42:
    buffer_load_dwordx4 v[212:215], v1, s[24:27], 0 offen offset:128 nt
    v_dot2c_f32_bf16 v44, v196, v24
    v_dot2c_f32_bf16 v44, v197, v25
    v_dot2c_f32_bf16 v44, v198, v26
    v_dot2c_f32_bf16 v44, v199, v27
    s_waitcnt vmcnt(7)
    s_bitcmp0_b32 s61, 6
    s_cbranch_scc1 L_p43
    s_waitcnt vmcnt(3)
    s_bitcmp0_b32 s62, 6
    s_cbranch_scc1 L_p43
    s_waitcnt vmcnt(2)
L_p43:
    buffer_load_dwordx4 v[216:219], v1, s[24:27], 0 offen offset:384 nt
    s_cmp_lg_u32 s22, 3
    s_cbranch_scc1 L_sh10
    s_lshl_b32 s10, s49, 8
    s_add_u32 s10, s10, 3
    v_mov_b32 v14, s10
    s_mov_b64 exec, 1
    buffer_store_dword v14, off, s[44:47], s19 sc1
    s_mov_b64 exec, -1
L_sh10:
    s_cmp_lg_u32 s22, 3
    s_cbranch_scc1 L_sh11
    v_and_b32 v12, 7, v0
    v_lshlrev_b32 v12, 9, v12
    s_andn2_b32 s10, s19, 0xe00
    s_mov_b64 exec, s[68:69]
    buffer_load_dword v13, v12, s[44:47], s10 offen sc1
    s_mov_b64 exec, -1
L_sh11:
    v_dot2c_f32_bf16 v44, v200, v16
    v_dot2c_f32_bf16 v44, v201, v17
    v_dot2c_f32_bf16 v44, v202, v18
    v_dot2c_f32_bf16 v44, v203, v19
    buffer_load_dwordx4 v[88:91], v2, s[40:43], s12 offen
    s_add_u32 s12, s12, 7168
    s_waitcnt vmcnt(5)
    s_bitcmp0_b32 s61, 7
    s_cbranch_scc1 L_p44
    s_waitcnt vmcnt(4)
    s_bitcmp0_b32 s62, 7
    s_cbranch_scc1 L_p44
    s_waitcnt vmcnt(2)
L_p44:
    buffer_load_dwordx4 v[220:223], v1, s[24:27], 0 offen offset:0 nt
    s_add_u32 s71, s71, 3
    v_sub_u32 v3, s71, v3
    s_mov_b32 exec_lo, 0
    v_add_u32 v3, -1, v3
    s_mov_b32 exec_lo, -1
    v_cmp_gt_u32 vcc, 5, v3
    v_cmp_gt_u32 s[10:11], 4, v3
    s_bcnt1_i32_b32 s7, vcc_hi
    s_bcnt1_i32_b32 s11, s11
    s_mul_i32 s7, s7, 4294967290
    s_lshl3_add_u32 s7, s11, s7
    s_mul_i32 s7, s7, 16
    s_ashr_i32 s7, s7, 3
    s_cmp_eq_u32 s3, 7
    s_cselect_b32 vcc_lo, -1, vcc_lo
    s_bcnt1_i32_b32 s70, vcc_lo
    v_cmp_gt_u32 vcc, 3, v3
    s_bcnt1_i32_b32 s10, s10
    s_add_u32 s70, s70, s10
    s_bcnt1_i32_b32 s10, vcc_lo
    s_add_u32 s70, s70, s10
    s_sub_i32 s70, s70, 45
    s_mul_i32 s70, s70, 24
    s_add_i32 s70, s70, s7
    s_ashr_i32 s70, s70, 3
    s_min_i32 s70, s70, 72
    s_max_i32 s70, s70, -72
    s_lshl3_add_u32 s10, s63, s3
    s_sub_i32 s10, s10, s67
    s_sub_i32 s10, s10, s70
    s_ashr_i32 s10, s10, 3
    s_min_i32 s65, s10, 16
    s_max_i32 s65, s65, 0
    s_bfm_b32 s61, s65, 0
    s_mul_i32 s61, s61, 0x10001
    s_lshr_b32 s61, s61, s64
    s_sub_i32 s65, s10, 16
    s_max_i32 s65, s65, 0
    s_min_i32 s65, s65, 16
    s_bfm_b32 s62, s65, 0
    s_mul_i32 s62, s62, 0x10001
    s_lshr_b32 s62, s62, s64
    v_dot2c_f32_bf16 v44, v204, v28
    v_dot2c_f32_bf16 v44, v205, v29
    v_dot2c_f32_bf16 v44, v206, v30
    v_dot2c_f32_bf16 v44, v207, v31
    v_xor_b32 v1, 0x94600, v1
    s_waitcnt vmcnt(5)
    s_bitcmp0_b32 s61, 8
    s_cbranch_scc1 L_p45
    s_waitcnt vmcnt(3)
    s_bitcmp0_b32 s62, 8
    s_cbranch_scc1 L_p45
    s_waitcnt vmcnt(2)
L_p45:
    buffer_load_dwordx4 v[228:231], v1, s[24:27], 0 offen offset:256 nt
    v_mov_b32 v45, 0
    v_dot2c_f32_bf16 v45, v208, v24
    v_dot2c_f32_bf16 v45, v209, v25
    v_dot2c_f32_bf16 v45, v210, v26
    v_dot2c_f32_bf16 v45, v211, v27
    buffer_load_dwordx4 v[92:95], v2, s[40:43], s12 offen
    s_add_u32 s12, s12, 7168
    s_waitcnt vmcnt(5)
    s_bitcmp0_b32 s61, 9
    s_cbranch_scc1 L_p46
    s_waitcnt vmcnt(4)
    s_bitcmp0_b32 s62, 9
    s_cbranch_scc1 L_p46
    s_waitcnt vmcnt(2)
L_p46:
    buffer_load_dwordx4 v[232:235], v1, s[24:27], 0 offen offset:128 nt
    v_dot2c_f32_bf16 v45, v212, v20
    v_dot2c_f32_bf16 v45, v213, v21
    v_dot2c_f32_bf16 v45, v214, v22
    v_dot2c_f32_bf16 v45, v215, v23
    s_waitcnt vmcnt(5)
    s_bitcmp0_b32 s61, 10
    s_cbranch_scc1 L_p47
    s_waitcnt vmcnt(3)
    s_bitcmp0_b32 s62, 10
    s_cbranch_scc1 L_p47
    s_waitcnt vmcnt(2)
L_p47:
    buffer_load_dwordx4 v[236:239], v1, s[24:27], 0 offen offset:384 nt
    v_dot2c_f32_bf16 v45, v216, v28
    v_dot2c_f32_bf16 v45, v217, v29
    v_dot2c_f32_bf16 v45, v218, v30
    v_dot2c_f32_bf16 v45, v219, v31
    s_waitcnt vmcnt(4)
    s_bitcmp0_b32 s61, 11
    s_cbranch_scc1 L_p48
    s_waitcnt vmcnt(3)
    s_bitcmp0_b32 s62, 11
    s_cbranch_scc1 L_p48
    s_waitcnt vmcnt(1)
L_p48:
    buffer_load_dwordx4 v[240:243], v1, s[24:27], 0 offen offset:0 nt
    s_cmp_lg_u32 s22, 3
    s_cbranch_scc1 L_sh12
    s_lshl_b32 s10, s8, 8
    s_add_u32 s10, s10, 0x3779b903
    v_cmp_eq_u32 vcc, s10, v13
    v_cmp_eq_u32 s[10:11], v14, v13
    v_subrev_u32 v14, 3, v14
    s_or_b64 vcc, vcc, s[10:11]
    v_lshrrev_b32 v12, 7, v12
    v_addc_co_u32 v14, vcc, 0, v14, vcc
    s_mov_b64 exec, s[68:69]
    buffer_store_dword v14, v12, s[44:47], s20 offen
    s_mov_b64 exec, -1
    s_nop 1
L_sh12:
    v_dot2c_f32_bf16 v45, v220, v16
    v_dot2c_f32_bf16 v45, v221, v17
    v_dot2c_f32_bf16 v45, v222, v18
    v_dot2c_f32_bf16 v45, v223, v19
    buffer_load_dwordx4 v[96:99], v2, s[40:43], s12 offen
    s_add_u32 s12, s12, 7168
    v_xor_b32 v1, 0x38600, v1
    s_waitcnt vmcnt(5)
    s_bitcmp0_b32 s61, 12
    s_cbranch_scc1 L_p49
    s_waitcnt vmcnt(3)
    s_bitcmp0_b32 s62, 12
    s_cbranch_scc1 L_p49
    s_waitcnt vmcnt(2)
L_p49:
    buffer_load_dwordx4 v[244:247], v1, s[24:27], 0 offen offset:128 nt
    v_mov_b32 v46, 0
    v_dot2c_f32_bf16 v46, v228, v24
    v_dot2c_f32_bf16 v46, v229, v25
    v_dot2c_f32_bf16 v46, v230, v26
    v_dot2c_f32_bf16 v46, v231, v27
    s_waitcnt vmcnt(4)
    s_bitcmp0_b32 s61, 13
    s_cbranch_scc1 L_p50
    s_waitcnt vmcnt(3)
    s_bitcmp0_b32 s62, 13
    s_cbranch_scc1 L_p50
    s_waitcnt vmcnt(2)
L_p50:
    buffer_load_dwordx4 v[248:251], v1, s[24:27], 0 offen offset:256 nt
    v_dot2c_f32_bf16 v46, v232, v20
    v_dot2c_f32_bf16 v46, v233, v21
    v_dot2c_f32_bf16 v46, v234, v22
    v_dot2c_f32_bf16 v46, v235, v23
    buffer_load_dwordx4 v[100:103], v2, s[40:43], s12 offen
    s_add_u32 s12, s12, 7168
    s_waitcnt vmcnt(5)
    s_bitcmp0_b32 s61, 14
    s_cbranch_scc1 L_p51
    s_waitcnt vmcnt(4)
    s_bitcmp0_b32 s62, 14
    s_cbranch_scc1 L_p51
    s_waitcnt vmcnt(2)
L_p51:
    buffer_load_dwordx4 v[252:255], v1, s[24:27], 0 offen offset:0 nt
    v_dot2c_f32_bf16 v46, v236, v28
    v_dot2c_f32_bf16 v46, v237, v29
    v_dot2c_f32_bf16 v46, v238, v30
    v_dot2c_f32_bf16 v46, v239, v31
    s_waitcnt vmcnt(5)
    s_bitcmp0_b32 s61, 15
    s_cbranch_scc1 L_p52
    s_waitcnt vmcnt(3)
    s_bitcmp0_b32 s62, 15
    s_cbranch_scc1 L_p52
    s_waitcnt vmcnt(2)
L_p52:
    buffer_load_dwordx4 v[192:195], v1, s[24:27], 0 offen offset:384 nt
    v_dot2c_f32_bf16 v46, v240, v16
    v_dot2c_f32_bf16 v46, v241, v17
L_t1:
    s_cbranch_execz L_r1
    v_dot2c_f32_bf16 v46, v242, v18
    v_dot2c_f32_bf16 v46, v243, v19
    buffer_load_dwordx4 v[104:107], v2, s[40:43], s12 offen
    s_add_u32 s12, s12, 7168
    v_xor_b32 v1, 0x1bd200, v1
    s_waitcnt vmcnt(5)
    s_bitcmp0_b32 s61, 0
    s_cbranch_scc1 L_p53
    s_waitcnt vmcnt(4)
    s_bitcmp0_b32 s62, 0
    s_cbranch_scc1 L_p53
    s_waitcnt vmcnt(2)
L_p53:
    buffer_load_dwordx4 v[196:199], v1, s[28:31], 0 offen offset:0 nt
    v_mov_b32 v47, 0
    v_dot2c_f32_bf16 v47, v244, v20
    v_dot2c_f32_bf16 v47, v245, v21
    v_dot2c_f32_bf16 v47, v246, v22
    v_dot2c_f32_bf16 v47, v247, v23
    s_waitcnt vmcnt(5)
    s_bitcmp0_b32 s61, 1
    s_cbranch_scc1 L_p54
    s_waitcnt vmcnt(3)
    s_bitcmp0_b32 s62, 1
    s_cbranch_scc1 L_p54
    s_waitcnt vmcnt(2)
L_p54:
    buffer_load_dwordx4 v[200:203], v1, s[28:31], 0 offen offset:384 nt
    v_dot2c_f32_bf16 v47, v248, v24
    v_dot2c_f32_bf16 v47, v249, v25
    v_dot2c_f32_bf16 v47, v250, v26
    v_dot2c_f32_bf16 v47, v251, v27
    buffer_load_dwordx4 v[108:111], v2, s[40:43], s12 offen
    s_add_u32 s12, s12, 7168
    s_waitcnt vmcnt(5)
    s_bitcmp0_b32 s61, 2
    s_cbranch_scc1 L_p55
    s_waitcnt vmcnt(4)
    s_bitcmp0_b32 s62, 2
    s_cbranch_scc1 L_p55
    s_waitcnt vmcnt(2)
L_p55:
    buffer_load_dwordx4 v[204:207], v1, s[28:31], 0 offen offset:128 nt
    s_lshl_b32 s71, s49, 8
    s_add_u32 s71, s71, 3
    v_mov_b32 v227, s71
    v_and_b32 v3, 63, v0
    v_lshlrev_b32 v3, 2, v3
    s_mov_b32 exec_lo, 0
    v_add_u32 v3, s21, v3
    s_mov_b64 exec, 1
    buffer_store_dword v227, off, s[44:47], s18
    s_mov_b64 exec, -1
    buffer_load_dword v3, v3, s[44:47], s16 offen
    v_dot2c_f32_bf16 v47, v252, v16
    v_dot2c_f32_bf16 v47, v253, v17
    v_dot2c_f32_bf16 v47, v254, v18
    v_dot2c_f32_bf16 v47, v255, v19
    s_waitcnt vmcnt(7)
    s_bitcmp0_b32 s61, 3
    s_cbranch_scc1 L_p56
    s_waitcnt vmcnt(5)
    s_bitcmp0_b32 s62, 3
    s_cbranch_scc1 L_p56
    s_waitcnt vmcnt(4)
L_p56:
    buffer_load_dwordx4 v[208:211], v1, s[28:31], 0 offen offset:256 nt
    v_dot2c_f32_bf16 v47, v192, v28
    v_dot2c_f32_bf16 v47, v193, v29
    v_dot2c_f32_bf16 v47, v194, v30
    v_dot2c_f32_bf16 v47, v195, v31
    v_add_f32_dpp v44, v44, v44 quad_perm:[1,0,3,2] row_mask:0xf bank_mask:0xf
    v_add_f32_dpp v45, v45, v45 quad_perm:[1,0,3,2] row_mask:0xf bank_mask:0xf
    v_add_f32_dpp v46, v46, v46 quad_perm:[1,0,3,2] row_mask:0xf bank_mask:0xf
    v_add_f32_dpp v47, v47, v47 quad_perm:[1,0,3,2] row_mask:0xf bank_mask:0xf
    v_add_f32_dpp v44, v44, v44 quad_perm:[2,3,0,1] row_mask:0xf bank_mask:0xf
    v_add_f32_dpp v45, v45, v45 quad_perm:[2,3,0,1] row_mask:0xf bank_mask:0xf
    v_add_f32_dpp v46, v46, v46 quad_perm:[2,3,0,1] row_mask:0xf bank_mask:0xf
    v_add_f32_dpp v47, v47, v47 quad_perm:[2,3,0,1] row_mask:0xf bank_mask:0xf
    v_add_f32_dpp v44, v44, v44 row_half_mirror row_mask:0xf bank_mask:0xf
    v_add_f32_dpp v45, v45, v45 row_half_mirror row_mask:0xf bank_mask:0xf
    v_add_f32_dpp v46, v46, v46 row_half_mirror row_mask:0xf bank_mask:0xf
    v_add_f32_dpp v47, v47, v47 row_half_mirror row_mask:0xf bank_mask:0xf
    v_cvt_pk_bf16_f32 v16, v32, v33
    v_cvt_pk_bf16_f32 v17, v34, v35
    v_cvt_pk_bf16_f32 v18, v36, v37
    v_cvt_pk_bf16_f32 v19, v38, v39
    v_cvt_pk_bf16_f32 v20, v40, v41
    v_cvt_pk_bf16_f32 v21, v42, v43
    v_cvt_pk_bf16_f32 v22, v44, v45
    v_cvt_pk_bf16_f32 v23, v46, v47
    v_lshlrev_b32 v32, 16, v16
    v_and_b32 v33, 0xffff0000, v16
    v_lshlrev_b32 v34, 16, v17
    v_and_b32 v35, 0xffff0000, v17
    v_lshlrev_b32 v36, 16, v18
    v_and_b32 v37, 0xffff0000, v18
    v_lshlrev_b32 v38, 16, v19
    v_and_b32 v39, 0xffff0000, v19
    v_lshlrev_b32 v40, 16, v20
    v_and_b32 v41, 0xffff0000, v20
    v_lshlrev_b32 v42, 16, v21
    v_and_b32 v43, 0xffff0000, v21
    v_lshlrev_b32 v44, 16, v22
    v_and_b32 v45, 0xffff0000, v22
    v_lshlrev_b32 v46, 16, v23
    v_and_b32 v47, 0xffff0000, v23
    v_max3_f32 v24, v32, v33, v34
    v_max3_f32 v24, v24, v35, v36
    v_max3_f32 v24, v24, v37, v38
    v_max3_f32 v24, v24, v39, v40
    v_max3_f32 v24, v24, v41, v42
    v_max3_f32 v24, v24, v43, v44
    v_max3_f32 v24, v24, v45, v46
    v_max_f32 v24, v24, v47
    s_nop 1
    v_max_f32_dpp v24, v24, v24 row_ror:8 row_mask:0xf bank_mask:0xf
    v_mov_b32 v25, v24
    s_nop 1
    v_permlane16_swap_b32 v24, v25
    v_max_f32 v24, v24, v25
    v_mov_b32 v25, v24
    s_nop 1
    v_permlane32_swap_b32 v24, v25
    v_max_f32 v24, v24, v25
    v_mul_f32 v24, s78, v24
    v_fma_f32 v32, v32, s78, -v24
    v_fma_f32 v33, v33, s78, -v24
    v_fma_f32 v34, v34, s78, -v24
    v_fma_f32 v35, v35, s78, -v24
    v_fma_f32 v36, v36, s78, -v24
    v_fma_f32 v37, v37, s78, -v24
    v_fma_f32 v38, v38, s78, -v24
    v_fma_f32 v39, v39, s78, -v24
    v_fma_f32 v40, v40, s78, -v24
    v_fma_f32 v41, v41, s78, -v24
    v_fma_f32 v42, v42, s78, -v24
    v_fma_f32 v43, v43, s78, -v24
    v_fma_f32 v44, v44, s78, -v24
    v_fma_f32 v45, v45, s78, -v24
    v_fma_f32 v46, v46, s78, -v24
    v_fma_f32 v47, v47, s78, -v24
    v_xor_b32 v1, 0x38600, v1
    s_waitcnt vmcnt(6)
    s_bitcmp0_b32 s61, 4
    s_cbranch_scc1 L_p57
    s_waitcnt vmcnt(5)
    s_bitcmp0_b32 s62, 4
    s_cbranch_scc1 L_p57
    s_waitcnt vmcnt(3)
L_p57:
    buffer_load_dwordx4 v[212:215], v1, s[28:31], 0 offen offset:384 nt
    v_exp_f32 v32, v32
    v_exp_f32 v33, v33
    v_exp_f32 v34, v34
    v_exp_f32 v35, v35
    v_exp_f32 v36, v36
    v_exp_f32 v37, v37
    v_exp_f32 v38, v38
    v_exp_f32 v39, v39
    v_exp_f32 v40, v40
    v_exp_f32 v41, v41
    v_exp_f32 v42, v42
    v_exp_f32 v43, v43
    v_exp_f32 v44, v44
    v_exp_f32 v45, v45
    v_exp_f32 v46, v46
    v_exp_f32 v47, v47
    v_add_f32 v26, v32, v33
    v_add_f32 v27, v34, v35
    v_add_f32 v26, v26, v36
    v_add_f32 v27, v27, v37
    v_add_f32 v26, v26, v38
    v_add_f32 v27, v27, v39
    v_add_f32 v26, v26, v40
    v_add_f32 v27, v27, v41
    v_add_f32 v26, v26, v42
    v_add_f32 v27, v27, v43
    v_add_f32 v26, v26, v44
    v_add_f32 v27, v27, v45
    v_add_f32 v26, v26, v46
    v_add_f32 v27, v27, v47
    v_add_f32 v26, v26, v27
    v_cvt_pk_bf16_f32 v32, v32, v32
    v_cvt_pk_bf16_f32 v33, v33, v33
    v_cvt_pk_bf16_f32 v34, v34, v34
    v_cvt_pk_bf16_f32 v35, v35, v35
    v_cvt_pk_bf16_f32 v36, v36, v36
    v_cvt_pk_bf16_f32 v37, v37, v37
    v_cvt_pk_bf16_f32 v38, v38, v38
    v_cvt_pk_bf16_f32 v39, v39, v39
    v_cvt_pk_bf16_f32 v40, v40, v40
    v_add_f32_dpp v26, v26, v26 row_ror:8 row_mask:0xf bank_mask:0xf
    v_mov_b32 v27, v26
    s_nop 1
    v_permlane16_swap_b32 v26, v27
    v_add_f32 v26, v26, v27
    v_mov_b32 v27, v26
    s_nop 1
    v_permlane32_swap_b32 v26, v27
    v_add_f32 v26, v26, v27
    v_mov_b32 v25, v26
    v_mov_b32 v29, v24
    v_lshrrev_b32 v28, 6, v0
    v_lshlrev_b32 v28, 3, v28
    ds_write_b64 v28, v[24:25] offset:47616
    v_mov_b32 v28, 0
    v_mov_b32 v26, 1
    s_mov_b64 exec, 1
    ds_add_u32 v28, v26 offset:47688
    s_mov_b64 exec, -1
    s_andn2_b32 s85, s2, 0x18
    s_lshl_b32 s85, s85, 9
    s_add_u32 s85, s85, 524288
    buffer_load_dwordx4 v[112:115], v2, s[40:43], s12 offen
    s_add_u32 s12, s12, 7168
    v_lshrrev_b32 v16, 5, v0
    v_mul_u32_u24 v16, 1088, v16
    v_and_b32 v22, 7, v0
    v_lshl_add_u32 v16, v22, 5, v16
    v_and_b32 v22, 16, v0
    v_add_u32 v16, v16, v22
    v_and_b32 v22, 7, v0
    v_mul_u32_u24 v17, 1088, v22
    v_and_b32 v22, 56, v0
    v_add_u32 v17, v22, v17
    s_lshl_b32 s86, s51, 6
    v_add_u32 v17, s86, v17
    v_bfe_u32 v19, v0, 3, 3
    v_mul_u32_u24 v19, 80, v19
    v_add_u32 v19, 17408, v19
    v_lshl_add_u32 v18, s51, 2, v19
    s_mov_b32 s74, 0x00ff00ff
    s_mov_b32 s75, 0
    s_mov_b32 s76, 0x01010101
    s_mov_b32 s77, 0x01010101
    v_and_b32 v20, 7, v0
    v_and_b32 v22, 16, v0
    v_lshl_add_u32 v20, v20, 5, v22
    v_lshl_add_u32 v20, s3, 8, v20
    v_bfe_u32 v21, v0, 2, 4
    v_lshlrev_b32 v21, 13, v21
    v_and_b32 v22, 3, v0
    v_lshl_add_u32 v21, v22, 4, v21
    v_and_b32 v23, 3, v0
    v_lshlrev_b32 v23, 12, v23
    s_mul_i32 s86, s79, 131072
    s_lshl_b32 s87, s80, 11
    s_add_u32 s89, s86, s87
    s_lshr_b32 s87, s80, 2
    s_xor_b32 s87, s87, s80
    s_and_b32 s87, s87, 12
    s_mul_i32 s87, s87, 5
    s_xor_b32 s80, s80, s87
    s_lshl_b32 s87, s80, 6
    s_add_u32 s88, s86, s87
    v_and_b32 v8, v32, v4
    v_and_b32 v9, v32, v5
    v_and_b32 v10, v32, v6
    v_and_b32 v11, v32, v7
    s_nop 1
    v_mfma_f32_16x16x32_bf16 v[48:51], v[8:11], v[196:199], 0
    s_waitcnt vmcnt(7)
    s_bitcmp0_b32 s61, 5
    s_cbranch_scc1 L_p58
    s_waitcnt vmcnt(5)
    s_bitcmp0_b32 s62, 5
    s_cbranch_scc1 L_p58
    s_waitcnt vmcnt(2)
L_p58:
    buffer_load_dwordx4 v[216:219], v1, s[28:31], 0 offen offset:0 nt
    v_mfma_f32_16x16x32_bf16 v[60:63], v[8:11], v[200:203], 0
    s_waitcnt vmcnt(6)
    s_bitcmp0_b32 s61, 6
    s_cbranch_scc1 L_p59
    s_waitcnt vmcnt(3)
    s_bitcmp0_b32 s62, 6
    s_cbranch_scc1 L_p59
    s_waitcnt vmcnt(2)
L_p59:
    buffer_load_dwordx4 v[220:223], v1, s[28:31], 0 offen offset:256 nt
    v_mfma_f32_16x16x32_bf16 v[52:55], v[8:11], v[204:207], 0
    buffer_load_dwordx4 v[116:119], v2, s[40:43], s12 offen
    s_add_u32 s12, s12, 7168
    s_waitcnt vmcnt(5)
    s_bitcmp0_b32 s61, 7
    s_cbranch_scc1 L_p60
    s_waitcnt vmcnt(4)
    s_bitcmp0_b32 s62, 7
    s_cbranch_scc1 L_p60
    s_waitcnt vmcnt(2)
L_p60:
    buffer_load_dwordx4 v[228:231], v1, s[28:31], 0 offen offset:128 nt
    s_add_u32 s71, s71, 3
    v_sub_u32 v3, s71, v3
    s_mov_b32 exec_lo, 0
    v_add_u32 v3, -2, v3
    s_mov_b32 exec_lo, -1
    v_cmp_gt_u32 vcc, 5, v3
    v_cmp_gt_u32 s[10:11], 4, v3
    s_bcnt1_i32_b32 s7, vcc_hi
    s_bcnt1_i32_b32 s11, s11
    s_mul_i32 s7, s7, 4294967290
    s_lshl3_add_u32 s7, s11, s7
    s_mul_i32 s7, s7, 16
    s_ashr_i32 s7, s7, 3
    s_bcnt1_i32_b32 s70, vcc_lo
    v_cmp_gt_u32 vcc, 3, v3
    s_bcnt1_i32_b32 s10, s10
    s_add_u32 s70, s70, s10
    s_bcnt1_i32_b32 s10, vcc_lo
    s_add_u32 s70, s70, s10
    s_sub_i32 s70, s70, 45
    s_mul_i32 s70, s70, 24
    s_add_i32 s70, s70, s7
    s_ashr_i32 s70, s70, 3
    s_min_i32 s70, s70, 72
    s_max_i32 s70, s70, -72
    s_lshl3_add_u32 s10, s63, s3
    s_sub_i32 s10, s10, s67
    s_sub_i32 s10, s10, s70
    s_ashr_i32 s10, s10, 3
    s_min_i32 s65, s10, 16
    s_max_i32 s65, s65, 0
    s_bfm_b32 s61, s65, 0
    s_mul_i32 s61, s61, 0x10001
    s_lshr_b32 s61, s61, s64
    s_sub_i32 s65, s10, 16
    s_max_i32 s65, s65, 0
    s_min_i32 s65, s65, 16
    s_bfm_b32 s62, s65, 0
    s_mul_i32 s62, s62, 0x10001
    s_lshr_b32 s62, s62, s64
    v_mfma_f32_16x16x32_bf16 v[56:59], v[8:11], v[208:211], 0
    v_xor_b32 v1, 0x94600, v1
    s_waitcnt vmcnt(5)
    s_bitcmp0_b32 s61, 8
    s_cbranch_scc1 L_p61
    s_waitcnt vmcnt(3)
    s_bitcmp0_b32 s62, 8
    s_cbranch_scc1 L_p61
    s_waitcnt vmcnt(2)
L_p61:
    buffer_load_dwordx4 v[232:235], v1, s[28:31], 0 offen offset:384 nt
    s_cmp_lg_u32 s22, 4
    s_cbranch_scc1 L_sh13
    s_lshl_b32 s10, s49, 8
    s_add_u32 s10, s10, 4
    v_mov_b32 v226, s10
    s_mov_b64 exec, 1
    buffer_store_dword v226, off, s[44:47], s19 sc1
    s_mov_b64 exec, -1
L_sh13:
    s_cmp_lg_u32 s22, 4
    s_cbranch_scc1 L_sh14
    v_and_b32 v224, 7, v0
    v_lshlrev_b32 v224, 9, v224
    s_andn2_b32 s10, s19, 0xe00
    s_mov_b64 exec, s[68:69]
    buffer_load_dword v225, v224, s[44:47], s10 offen sc1
    s_mov_b64 exec, -1
L_sh14:
    v_and_b32 v12, v33, v4
    v_and_b32 v13, v33, v5
    v_and_b32 v14, v33, v6
    v_and_b32 v15, v33, v7
    s_nop 1
    v_mfma_f32_16x16x32_bf16 v[60:63], v[12:15], v[212:215], v[60:63]
    buffer_load_dwordx4 v[120:123], v2, s[40:43], s12 offen
    s_add_u32 s12, s12, 7168
    s_waitcnt vmcnt(5)
    s_bitcmp0_b32 s61, 9
    s_cbranch_scc1 L_p62
    s_waitcnt vmcnt(4)
    s_bitcmp0_b32 s62, 9
    s_cbranch_scc1 L_p62
    s_waitcnt vmcnt(2)
L_p62:
    buffer_load_dwordx4 v[236:239], v1, s[28:31], 0 offen offset:0 nt
    v_mfma_f32_16x16x32_bf16 v[48:51], v[12:15], v[216:219], v[48:51]
    s_lshl_b32 s63, s3, 2
    s_lshr_b32 s63, 0x40001223, s63
    s_and_b32 s63, s63, 15
    s_add_u32 s63, s63, 20
    s_waitcnt vmcnt(5)
    s_bitcmp0_b32 s61, 10
    s_cbranch_scc1 L_p63
    s_waitcnt vmcnt(3)
    s_bitcmp0_b32 s62, 10
    s_cbranch_scc1 L_p63
    s_waitcnt vmcnt(2)
L_p63:
    buffer_load_dwordx4 v[240:243], v1, s[28:31], 0 offen offset:256 nt
    s_lshl3_add_u32 s10, s63, s3
    s_sub_i32 s10, s10, s67
    s_sub_i32 s10, s10, s70
    s_ashr_i32 s10, s10, 3
    s_min_i32 s65, s10, 16
    s_max_i32 s65, s65, 0
    s_bfm_b32 s61, s65, 0
    s_mul_i32 s61, s61, 0x10001
    s_lshr_b32 s61, s61, s64
    s_sub_i32 s65, s10, 16
    s_max_i32 s65, s65, 0
    s_min_i32 s65, s65, 16
    s_bfm_b32 s62, s65, 0
    s_mul_i32 s62, s62, 0x10001
    s_lshr_b32 s62, s62, s64
    v_mfma_f32_16x16x32_bf16 v[56:59], v[12:15], v[220:223], v[56:59]
    buffer_load_dwordx4 v[124:127], v2, s[40:43], s12 offen
    s_add_u32 s12, s12, 7168
    s_waitcnt vmcnt(5)
    s_bitcmp0_b32 s61, 11
    s_cbranch_scc1 L_p64
    s_waitcnt vmcnt(4)
    s_bitcmp0_b32 s62, 11
    s_cbranch_scc1 L_p64
    s_waitcnt vmcnt(2)
L_p64:
    buffer_load_dwordx4 v[244:247], v1, s[28:31], 0 offen offset:128 nt
    v_mfma_f32_16x16x32_bf16 v[52:55], v[12:15], v[228:231], v[52:55]
    s_cmp_lg_u32 s3, 7
    s_cbranch_scc1 L_ml1
    v_and_b32 v28, 7, v0
    v_lshlrev_b32 v28, 3, v28
    v_mov_b32 v30, 0
    s_mov_b32 s81, 0
    s_nop 1
L_c2:
    ds_read_b32 v24, v30 offset:47688
    ds_read_b64 v[26:27], v28 offset:47616
    s_waitcnt lgkmcnt(0)
    v_readfirstlane_b32 s86, v24
    s_nop 0
    s_cmp_ge_u32 s86, 8
    s_cbranch_scc1 L_c2ok
    s_add_u32 s81, s81, 1
    s_cmp_lt_u32 s81, 4000000
    s_sleep 1
    s_cbranch_scc1 L_c2
L_c2ok:
    v_mov_b32 v24, v26
    s_nop 1
    v_max_f32_dpp v24, v24, v24 quad_perm:[1,0,3,2] row_mask:0xf bank_mask:0xf
    s_nop 1
    v_max_f32_dpp v24, v24, v24 quad_perm:[2,3,0,1] row_mask:0xf bank_mask:0xf
    s_nop 1
    v_max_f32_dpp v24, v24, v24 row_half_mirror row_mask:0xf bank_mask:0xf
    v_sub_f32 v26, v26, v24
    v_exp_f32 v26, v26
    s_nop 0
    v_mul_f32 v25, v26, v27
    s_nop 1
    v_add_f32_dpp v25, v25, v25 quad_perm:[1,0,3,2] row_mask:0xf bank_mask:0xf
    s_nop 1
    v_add_f32_dpp v25, v25, v25 quad_perm:[2,3,0,1] row_mask:0xf bank_mask:0xf
    s_nop 1
    v_add_f32_dpp v25, v25, v25 row_half_mirror row_mask:0xf bank_mask:0xf
    v_mov_b32 v26, s49
    v_mov_b32 v27, s49
    s_and_b32 s87, s80, 3
    s_lshl_b32 s87, s87, 12
    v_mov_b32 v28, s87
    s_mov_b64 exec, 1
    buffer_store_dwordx4 v[24:27], v28, s[44:47], s85 offen sc1
    s_mov_b64 exec, -1
    s_nop 0
L_ml1:
    v_xor_b32 v1, 0x38600, v1
    s_waitcnt vmcnt(5)
    s_bitcmp0_b32 s61, 12
    s_cbranch_scc1 L_p65
    s_waitcnt vmcnt(3)
    s_bitcmp0_b32 s62, 12
    s_cbranch_scc1 L_p65
    s_waitcnt vmcnt(2)
L_p65:
    buffer_load_dwordx4 v[248:251], v1, s[28:31], 0 offen offset:0 nt
    v_and_b32 v8, v34, v4
    v_and_b32 v9, v34, v5
    v_and_b32 v10, v34, v6
    v_and_b32 v11, v34, v7
    s_nop 1
    v_mfma_f32_16x16x32_bf16 v[60:63], v[8:11], v[232:235], v[60:63]
    s_waitcnt vmcnt(4)
    s_bitcmp0_b32 s61, 13
    s_cbranch_scc1 L_p66
    s_waitcnt vmcnt(3)
    s_bitcmp0_b32 s62, 13
    s_cbranch_scc1 L_p66
    s_waitcnt vmcnt(1)
L_p66:
    buffer_load_dwordx4 v[252:255], v1, s[28:31], 0 offen offset:384 nt
    s_cmp_lg_u32 s22, 4
    s_cbranch_scc1 L_sh15
    s_lshl_b32 s10, s8, 8
    s_add_u32 s10, s10, 0x3779b904
    v_cmp_eq_u32 vcc, s10, v225
    v_cmp_eq_u32 s[10:11], v226, v225
    v_subrev_u32 v226, 4, v226
    s_or_b64 vcc, vcc, s[10:11]
    v_lshrrev_b32 v224, 7, v224
    v_addc_co_u32 v226, vcc, 0, v226, vcc
    s_mov_b64 exec, s[68:69]
    buffer_store_dword v226, v224, s[44:47], s20 offen
    s_mov_b64 exec, -1
    s_nop 1
L_sh15:
    v_mfma_f32_16x16x32_bf16 v[48:51], v[8:11], v[236:239], v[48:51]
    buffer_load_dwordx4 v[128:131], v2, s[40:43], s12 offen
    s_add_u32 s12, s12, 7168
    s_waitcnt vmcnt(5)
    s_bitcmp0_b32 s61, 14
    s_cbranch_scc1 L_p67
    s_waitcnt vmcnt(3)
    s_bitcmp0_b32 s62, 14
    s_cbranch_scc1 L_p67
    s_waitcnt vmcnt(2)
L_p67:
    buffer_load_dwordx4 v[192:195], v1, s[28:31], 0 offen offset:128 nt
    v_mfma_f32_16x16x32_bf16 v[56:59], v[8:11], v[240:243], v[56:59]
    s_waitcnt vmcnt(4)
    s_bitcmp0_b32 s61, 15
    s_cbranch_scc1 L_p68
    s_waitcnt vmcnt(3)
    s_bitcmp0_b32 s62, 15
    s_cbranch_scc1 L_p68
    s_waitcnt vmcnt(2)
L_p68:
    buffer_load_dwordx4 v[196:199], v1, s[28:31], 0 offen offset:256 nt
    v_mfma_f32_16x16x32_bf16 v[52:55], v[8:11], v[244:247], v[52:55]
    buffer_load_dwordx4 v[132:135], v2, s[40:43], s12 offen
    s_add_u32 s12, s12, 7168
    v_xor_b32 v1, 0x58a00, v1
    s_waitcnt vmcnt(5)
    s_bitcmp0_b32 s61, 0
    s_cbranch_scc1 L_p69
    s_waitcnt vmcnt(4)
    s_bitcmp0_b32 s62, 0
    s_cbranch_scc1 L_p69
    s_waitcnt vmcnt(2)
L_p69:
    buffer_load_dwordx4 v[200:203], v1, s[28:31], 0 offen offset:0 nt
    s_lshl_b32 s71, s49, 8
    s_add_u32 s71, s71, 4
    v_mov_b32 v227, s71
    v_and_b32 v3, 63, v0
    v_lshlrev_b32 v3, 2, v3
    s_mov_b32 exec_lo, 0
    v_add_u32 v3, s21, v3
    s_mov_b64 exec, 1
    buffer_store_dword v227, off, s[44:47], s18
    s_mov_b64 exec, -1
    buffer_load_dword v3, v3, s[44:47], s16 offen
    v_and_b32 v12, v35, v4
    v_and_b32 v13, v35, v5
    v_and_b32 v14, v35, v6
    v_and_b32 v15, v35, v7
    s_nop 1
    v_mfma_f32_16x16x32_bf16 v[48:51], v[12:15], v[248:251], v[48:51]
    s_waitcnt vmcnt(7)
    s_bitcmp0_b32 s61, 1
    s_cbranch_scc1 L_p70
    s_waitcnt vmcnt(5)
    s_bitcmp0_b32 s62, 1
    s_cbranch_scc1 L_p70
    s_waitcnt vmcnt(4)
L_p70:
    buffer_load_dwordx4 v[204:207], v1, s[28:31], 0 offen offset:384 nt
    v_mfma_f32_16x16x32_bf16 v[60:63], v[12:15], v[252:255], v[60:63]
    buffer_load_dwordx4 v[136:139], v2, s[40:43], s12 offen
    s_add_u32 s12, s12, 7168
    s_waitcnt vmcnt(7)
    s_bitcmp0_b32 s61, 2
    s_cbranch_scc1 L_p71
    s_waitcnt vmcnt(6)
    s_bitcmp0_b32 s62, 2
    s_cbranch_scc1 L_p71
    s_waitcnt vmcnt(4)
L_p71:
    buffer_load_dwordx4 v[208:211], v1, s[28:31], 0 offen offset:128 nt
    v_mfma_f32_16x16x32_bf16 v[52:55], v[12:15], v[192:195], v[52:55]
    s_waitcnt vmcnt(7)
    s_bitcmp0_b32 s61, 3
    s_cbranch_scc1 L_p72
    s_waitcnt vmcnt(5)
    s_bitcmp0_b32 s62, 3
    s_cbranch_scc1 L_p72
    s_waitcnt vmcnt(2)
L_p72:
    buffer_load_dwordx4 v[212:215], v1, s[28:31], 0 offen offset:256 nt
    v_mfma_f32_16x16x32_bf16 v[56:59], v[12:15], v[196:199], v[56:59]
    buffer_load_dwordx4 v[140:143], v2, s[40:43], s12 offen
    s_add_u32 s12, s12, 7168
    v_xor_b32 v1, 0x38600, v1
    s_waitcnt vmcnt(7)
    s_bitcmp0_b32 s61, 4
    s_cbranch_scc1 L_p73
    s_waitcnt vmcnt(4)
    s_bitcmp0_b32 s62, 4
    s_cbranch_scc1 L_p73
    s_waitcnt vmcnt(2)
L_p73:
    buffer_load_dwordx4 v[216:219], v1, s[28:31], 0 offen offset:384 nt
    s_cmp_lg_u32 s22, 5
    s_cbranch_scc1 L_sh16
    s_lshl_b32 s10, s49, 8
    s_add_u32 s10, s10, 5
    v_mov_b32 v226, s10
    s_mov_b64 exec, 1
    buffer_store_dword v226, off, s[44:47], s19 sc1
    s_mov_b64 exec, -1
L_sh16:
    s_cmp_lg_u32 s22, 5
    s_cbranch_scc1 L_sh17
    v_and_b32 v224, 7, v0
    v_lshlrev_b32 v224, 9, v224
    s_andn2_b32 s10, s19, 0xe00
    s_mov_b64 exec, s[68:69]
    buffer_load_dword v225, v224, s[44:47], s10 offen sc1
    s_mov_b64 exec, -1
L_sh17:
    v_and_b32 v8, v36, v4
    v_and_b32 v9, v36, v5
    v_and_b32 v10, v36, v6
    v_and_b32 v11, v36, v7
    s_nop 1
    v_mfma_f32_16x16x32_bf16 v[48:51], v[8:11], v[200:203], v[48:51]
    s_waitcnt vmcnt(5)
    s_bitcmp0_b32 s61, 5
    s_cbranch_scc1 L_p74
    s_waitcnt vmcnt(3)
    s_bitcmp0_b32 s62, 5
    s_cbranch_scc1 L_p74
    s_waitcnt vmcnt(2)
L_p74:
    buffer_load_dwordx4 v[220:223], v1, s[28:31], 0 offen offset:0 nt
    s_add_u32 s71, s71, 3
    v_sub_u32 v3, s71, v3
    s_mov_b32 exec_lo, 0
    v_add_u32 v3, -3, v3
    s_mov_b32 exec_lo, -1
    v_cmp_gt_u32 vcc, 5, v3
    v_cmp_gt_u32 s[10:11], 4, v3
    s_bcnt1_i32_b32 s7, vcc_hi
    s_bcnt1_i32_b32 s11, s11
    s_mul_i32 s7, s7, 4294967290
    s_lshl3_add_u32 s7, s11, s7
    s_mul_i32 s7, s7, 16
    s_ashr_i32 s7, s7, 3
    s_bcnt1_i32_b32 s70, vcc_lo
    v_cmp_gt_u32 vcc, 3, v3
    s_bcnt1_i32_b32 s10, s10
    s_add_u32 s70, s70, s10
    s_bcnt1_i32_b32 s10, vcc_lo
    s_add_u32 s70, s70, s10
    s_sub_i32 s70, s70, 45
    s_mul_i32 s70, s70, 24
    s_add_i32 s70, s70, s7
    s_ashr_i32 s70, s70, 3
    s_min_i32 s70, s70, 72
    s_max_i32 s70, s70, -72
    s_lshl3_add_u32 s10, s63, s3
    s_sub_i32 s10, s10, s67
    s_sub_i32 s10, s10, s70
    s_ashr_i32 s10, s10, 3
    s_min_i32 s65, s10, 16
    s_max_i32 s65, s65, 0
    s_bfm_b32 s61, s65, 0
    s_mul_i32 s61, s61, 0x10001
    s_lshr_b32 s61, s61, s64
    s_sub_i32 s65, s10, 16
    s_max_i32 s65, s65, 0
    s_min_i32 s65, s65, 16
    s_bfm_b32 s62, s65, 0
    s_mul_i32 s62, s62, 0x10001
    s_lshr_b32 s62, s62, s64
    v_mfma_f32_16x16x32_bf16 v[60:63], v[8:11], v[204:207], v[60:63]
    s_waitcnt vmcnt(4)
    s_bitcmp0_b32 s61, 6
    s_cbranch_scc1 L_p75
    s_waitcnt vmcnt(3)
    s_bitcmp0_b32 s62, 6
    s_cbranch_scc1 L_p75
    s_waitcnt vmcnt(1)
L_p75:
    buffer_load_dwordx4 v[228:231], v1, s[28:31], 0 offen offset:256 nt
    v_mfma_f32_16x16x32_bf16 v[52:55], v[8:11], v[208:211], v[52:55]
    buffer_load_dwordx4 v[144:147], v2, s[40:43], s12 offen
    s_add_u32 s12, s12, 7168
    s_waitcnt vmcnt(5)
    s_bitcmp0_b32 s61, 7
    s_cbranch_scc1 L_p76
    s_waitcnt vmcnt(3)
    s_bitcmp0_b32 s62, 7
    s_cbranch_scc1 L_p76
    s_waitcnt vmcnt(2)
L_p76:
    buffer_load_dwordx4 v[232:235], v1, s[28:31], 0 offen offset:128 nt
    v_mfma_f32_16x16x32_bf16 v[56:59], v[8:11], v[212:215], v[56:59]
    v_xor_b32 v1, 0x94600, v1
    s_waitcnt vmcnt(4)
    s_bitcmp0_b32 s61, 8
    s_cbranch_scc1 L_p77
    s_waitcnt vmcnt(3)
    s_bitcmp0_b32 s62, 8
    s_cbranch_scc1 L_p77
    s_waitcnt vmcnt(2)
L_p77:
    buffer_load_dwordx4 v[236:239], v1, s[28:31], 0 offen offset:384 nt
    v_and_b32 v12, v37, v4
    v_and_b32 v13, v37, v5
    v_and_b32 v14, v37, v6
    v_and_b32 v15, v37, v7
    s_nop 1
    v_mfma_f32_16x16x32_bf16 v[60:63], v[12:15], v[216:219], v[60:63]
    buffer_load_dwordx4 v[148:151], v2, s[40:43], s12 offen
    s_add_u32 s12, s12, 7168
    s_waitcnt vmcnt(5)
    s_bitcmp0_b32 s61, 9
    s_cbranch_scc1 L_p78
    s_waitcnt vmcnt(4)
    s_bitcmp0_b32 s62, 9
    s_cbranch_scc1 L_p78
    s_waitcnt vmcnt(2)
L_p78:
    buffer_load_dwordx4 v[240:243], v1, s[28:31], 0 offen offset:0 nt
    s_cmp_lg_u32 s22, 5
    s_cbranch_scc1 L_sh18
    s_lshl_b32 s10, s8, 8
    s_add_u32 s10, s10, 0x3779b905
    v_cmp_eq_u32 vcc, s10, v225
    v_cmp_eq_u32 s[10:11], v226, v225
    v_subrev_u32 v226, 5, v226
    s_or_b64 vcc, vcc, s[10:11]
    v_lshrrev_b32 v224, 7, v224
    v_addc_co_u32 v226, vcc, 0, v226, vcc
    s_mov_b64 exec, s[68:69]
    buffer_store_dword v226, v224, s[44:47], s20 offen
    s_mov_b64 exec, -1
    s_nop 1
L_sh18:
    v_mfma_f32_16x16x32_bf16 v[48:51], v[12:15], v[220:223], v[48:51]
    s_waitcnt vmcnt(5)
    s_bitcmp0_b32 s61, 10
    s_cbranch_scc1 L_p79
    s_waitcnt vmcnt(3)
    s_bitcmp0_b32 s62, 10
    s_cbranch_scc1 L_p79
    s_waitcnt vmcnt(2)
L_p79:
    buffer_load_dwordx4 v[244:247], v1, s[28:31], 0 offen offset:256 nt
    v_mfma_f32_16x16x32_bf16 v[56:59], v[12:15], v[228:231], v[56:59]
    buffer_load_dwordx4 v[152:155], v2, s[40:43], s12 offen
    s_add_u32 s12, s12, 7168
    s_waitcnt vmcnt(5)
    s_bitcmp0_b32 s61, 11
    s_cbranch_scc1 L_p80
    s_waitcnt vmcnt(4)
    s_bitcmp0_b32 s62, 11
    s_cbranch_scc1 L_p80
    s_waitcnt vmcnt(2)
L_p80:
    buffer_load_dwordx4 v[248:251], v1, s[28:31], 0 offen offset:128 nt
    v_mfma_f32_16x16x32_bf16 v[52:55], v[12:15], v[232:235], v[52:55]
    v_xor_b32 v1, 0x38600, v1
    s_waitcnt vmcnt(5)
    s_bitcmp0_b32 s61, 12
    s_cbranch_scc1 L_p81
    s_waitcnt vmcnt(3)
    s_bitcmp0_b32 s62, 12
    s_cbranch_scc1 L_p81
    s_waitcnt vmcnt(2)
L_p81:
    buffer_load_dwordx4 v[192:195], v1, s[28:31], 0 offen offset:0 nt
    s_lshl_b32 s71, s49, 8
    s_add_u32 s71, s71, 5
    v_mov_b32 v227, s71
    v_and_b32 v3, 63, v0
    v_lshlrev_b32 v3, 2, v3
    s_mov_b32 exec_lo, 0
    v_add_u32 v3, s21, v3
    s_mov_b64 exec, 1
    buffer_store_dword v227, off, s[44:47], s18
    s_mov_b64 exec, -1
    buffer_load_dword v3, v3, s[44:47], s16 offen
    v_and_b32 v8, v38, v4
    v_and_b32 v9, v38, v5
    v_and_b32 v10, v38, v6
    v_and_b32 v11, v38, v7
    s_nop 1
    v_mfma_f32_16x16x32_bf16 v[60:63], v[8:11], v[236:239], v[60:63]
    buffer_load_dwordx4 v[156:159], v2, s[40:43], s12 offen
    s_add_u32 s12, s12, 7168
    s_waitcnt vmcnt(7)
    s_bitcmp0_b32 s61, 13
    s_cbranch_scc1 L_p82
    s_waitcnt vmcnt(6)
    s_bitcmp0_b32 s62, 13
    s_cbranch_scc1 L_p82
    s_waitcnt vmcnt(4)
L_p82:
    buffer_load_dwordx4 v[196:199], v1, s[28:31], 0 offen offset:384 nt
    v_mfma_f32_16x16x32_bf16 v[48:51], v[8:11], v[240:243], v[48:51]
    s_waitcnt vmcnt(7)
    s_bitcmp0_b32 s61, 14
    s_cbranch_scc1 L_p83
    s_waitcnt vmcnt(5)
    s_bitcmp0_b32 s62, 14
    s_cbranch_scc1 L_p83
    s_waitcnt vmcnt(4)
L_p83:
    buffer_load_dwordx4 v[200:203], v1, s[28:31], 0 offen offset:128 nt
    v_mfma_f32_16x16x32_bf16 v[56:59], v[8:11], v[244:247], v[56:59]
    s_waitcnt vmcnt(6)
    s_bitcmp0_b32 s61, 15
    s_cbranch_scc1 L_p84
    s_waitcnt vmcnt(5)
    s_bitcmp0_b32 s62, 15
    s_cbranch_scc1 L_p84
    s_waitcnt vmcnt(1)
L_p84:
    buffer_load_dwordx4 v[204:207], v1, s[28:31], 0 offen offset:256 nt
    v_mfma_f32_16x16x32_bf16 v[52:55], v[8:11], v[248:251], v[52:55]
    buffer_load_dwordx4 v[160:163], v2, s[40:43], s12 offen
    s_add_u32 s12, s12, 7168
    v_xor_b32 v1, 0x1bd200, v1
    s_waitcnt vmcnt(7)
    s_bitcmp0_b32 s61, 0
    s_cbranch_scc1 L_p85
    s_waitcnt vmcnt(3)
    s_bitcmp0_b32 s62, 0
    s_cbranch_scc1 L_p85
    s_waitcnt vmcnt(2)
L_p85:
    buffer_load_dwordx4 v[208:211], v1, s[28:31], 0 offen offset:128 nt
    v_and_b32 v12, v39, v4
    v_and_b32 v13, v39, v5
    v_and_b32 v14, v39, v6
    v_and_b32 v15, v39, v7
    s_nop 1
    v_mfma_f32_16x16x32_bf16 v[48:51], v[12:15], v[192:195], v[48:51]
    s_waitcnt vmcnt(4)
L_t2:
    s_cbranch_execz L_r2
    s_bitcmp0_b32 s61, 1
    s_cbranch_scc1 L_p86
    s_waitcnt vmcnt(3)
    s_bitcmp0_b32 s62, 1
    s_cbranch_scc1 L_p86
    s_waitcnt vmcnt(2)
L_p86:
    buffer_load_dwordx4 v[212:215], v1, s[28:31], 0 offen offset:256 nt
    s_add_u32 s71, s71, 3
    v_sub_u32 v3, s71, v3
    s_mov_b32 exec_lo, 0
    v_add_u32 v3, -4, v3
    s_mov_b32 exec_lo, -1
    v_cmp_gt_u32 vcc, 5, v3
    v_cmp_gt_u32 s[10:11], 4, v3
    s_bcnt1_i32_b32 s7, vcc_hi
    s_bcnt1_i32_b32 s11, s11
    s_mul_i32 s7, s7, 4294967290
    s_lshl3_add_u32 s7, s11, s7
    s_mul_i32 s7, s7, 16
    s_ashr_i32 s7, s7, 3
    s_bcnt1_i32_b32 s70, vcc_lo
    v_cmp_gt_u32 vcc, 3, v3
    s_bcnt1_i32_b32 s10, s10
    s_add_u32 s70, s70, s10
    s_bcnt1_i32_b32 s10, vcc_lo
    s_add_u32 s70, s70, s10
    s_sub_i32 s70, s70, 45
    s_mul_i32 s70, s70, 24
    s_add_i32 s70, s70, s7
    s_ashr_i32 s70, s70, 3
    s_min_i32 s70, s70, 72
    s_max_i32 s70, s70, -72
    s_lshl3_add_u32 s10, s63, s3
    s_sub_i32 s10, s10, s67
    s_sub_i32 s10, s10, s70
    s_ashr_i32 s10, s10, 3
    s_min_i32 s65, s10, 16
    s_max_i32 s65, s65, 0
    s_bfm_b32 s61, s65, 0
    s_mul_i32 s61, s61, 0x10001
    s_lshr_b32 s61, s61, s64
    s_sub_i32 s65, s10, 16
    s_max_i32 s65, s65, 0
    s_min_i32 s65, s65, 16
    s_bfm_b32 s62, s65, 0
    s_mul_i32 s62, s62, 0x10001
    s_lshr_b32 s62, s62, s64
    v_mfma_f32_16x16x32_bf16 v[60:63], v[12:15], v[196:199], v[60:63]
    buffer_load_dwordx4 v[164:167], v2, s[40:43], s12 offen
    s_add_u32 s12, s12, 7168
    s_waitcnt vmcnt(5)
    s_bitcmp0_b32 s61, 2
    s_cbranch_scc1 L_p87
    s_waitcnt vmcnt(4)
    s_bitcmp0_b32 s62, 2
    s_cbranch_scc1 L_p87
    s_waitcnt vmcnt(2)
L_p87:
    buffer_load_dwordx4 v[216:219], v1, s[28:31], 0 offen offset:0 nt
    v_mfma_f32_16x16x32_bf16 v[52:55], v[12:15], v[200:203], v[52:55]
    s_waitcnt vmcnt(5)
    s_bitcmp0_b32 s61, 3
    s_cbranch_scc1 L_p88
    s_waitcnt vmcnt(3)
    s_bitcmp0_b32 s62, 3
    s_cbranch_scc1 L_p88
    s_waitcnt vmcnt(2)
L_p88:
    buffer_load_dwordx4 v[220:223], v1, s[28:31], 0 offen offset:384 nt
    v_mfma_f32_16x16x32_bf16 v[56:59], v[12:15], v[204:207], v[56:59]
    s_cmp_lg_u32 s3, 7
    s_cbranch_scc1 L_ml2
    buffer_load_dwordx4 v[24:27], v23, s[44:47], s85 offen sc1
    s_nop 4
L_ml2:
    buffer_load_dwordx4 v[168:171], v2, s[40:43], s12 offen
    s_add_u32 s12, s12, 7168
    v_xor_b32 v1, 0x38600, v1
    s_waitcnt vmcnt(5)
    s_bitcmp0_b32 s61, 4
    s_cbranch_scc1 L_p89
    s_waitcnt vmcnt(4)
    s_bitcmp0_b32 s62, 4
    s_cbranch_scc1 L_p89
    s_waitcnt vmcnt(2)
L_p89:
    buffer_load_dwordx4 v[228:231], v1, s[28:31], 0 offen offset:256 nt
    v_and_b32 v8, v40, v4
    v_and_b32 v9, v40, v5
    v_and_b32 v10, v40, v6
    v_and_b32 v11, v40, v7
    s_nop 1
    v_mfma_f32_16x16x32_bf16 v[52:55], v[8:11], v[208:211], v[52:55]
    s_waitcnt vmcnt(5)
    s_bitcmp0_b32 s61, 5
    s_cbranch_scc1 L_p90
    s_waitcnt vmcnt(3)
    s_bitcmp0_b32 s62, 5
    s_cbranch_scc1 L_p90
    s_waitcnt vmcnt(2)
L_p90:
    buffer_load_dwordx4 v[232:235], v1, s[28:31], 0 offen offset:128 nt
    v_mfma_f32_16x16x32_bf16 v[56:59], v[8:11], v[212:215], v[56:59]
    buffer_load_dwordx4 v[172:175], v2, s[40:43], s12 offen
    s_add_u32 s12, s12, 7168
    s_waitcnt vmcnt(5)
    s_bitcmp0_b32 s61, 6
    s_cbranch_scc1 L_p91
    s_waitcnt vmcnt(4)
    s_bitcmp0_b32 s62, 6
    s_cbranch_scc1 L_p91
    s_waitcnt vmcnt(2)
L_p91:
    buffer_load_dwordx4 v[236:239], v1, s[28:31], 0 offen offset:0 nt
    s_lshl_b32 s71, s49, 8
    s_add_u32 s71, s71, 6
    v_mov_b32 v227, s71
    v_and_b32 v3, 63, v0
    v_lshlrev_b32 v3, 2, v3
    s_mov_b32 exec_lo, 0
    v_add_u32 v3, s21, v3
    s_mov_b64 exec, 1
    buffer_store_dword v227, off, s[44:47], s18
    s_mov_b64 exec, -1
    buffer_load_dword v3, v3, s[44:47], s16 offen
    v_mfma_f32_16x16x32_bf16 v[48:51], v[8:11], v[216:219], v[48:51]
    v_xor_b32 v1, 0x94600, v1
    s_waitcnt vmcnt(7)
    s_bitcmp0_b32 s61, 7
    s_cbranch_scc1 L_p92
    s_waitcnt vmcnt(5)
    s_bitcmp0_b32 s62, 7
    s_cbranch_scc1 L_p92
    s_waitcnt vmcnt(4)
L_p92:
    buffer_load_dwordx4 v[240:243], v1, s[28:31], 0 offen offset:256 nt
    v_mfma_f32_16x16x32_bf16 v[60:63], v[8:11], v[220:223], v[60:63]
    s_waitcnt vmcnt(6)
    s_bitcmp0_b32 s61, 8
    s_cbranch_scc1 L_p93
    s_waitcnt vmcnt(5)
    s_bitcmp0_b32 s62, 8
    s_cbranch_scc1 L_p93
    s_waitcnt vmcnt(3)
L_p93:
    buffer_load_dwordx4 v[244:247], v1, s[28:31], 0 offen offset:128 nt
    v_cvt_pk_bf16_f32 v15, v41, v41
    v_and_b32 v12, v15, v4
    v_and_b32 v13, v15, v5
    v_and_b32 v14, v15, v6
    v_and_b32 v15, v15, v7
    s_nop 1
    v_mfma_f32_16x16x32_bf16 v[56:59], v[12:15], v[228:231], v[56:59]
    buffer_load_dwordx4 v[176:179], v2, s[40:43], s12 offen
    s_add_u32 s12, s12, 7168
    s_waitcnt vmcnt(7)
    s_bitcmp0_b32 s61, 9
    s_cbranch_scc1 L_p94
    s_waitcnt vmcnt(5)
    s_bitcmp0_b32 s62, 9
    s_cbranch_scc1 L_p94
    s_waitcnt vmcnt(2)
L_p94:
    buffer_load_dwordx4 v[248:251], v1, s[28:31], 0 offen offset:0 nt
    v_mfma_f32_16x16x32_bf16 v[52:55], v[12:15], v[232:235], v[52:55]
    v_xor_b32 v1, 0x38600, v1
    s_waitcnt vmcnt(6)
    s_bitcmp0_b32 s61, 10
    s_cbranch_scc1 L_p95
    s_waitcnt vmcnt(3)
    s_bitcmp0_b32 s62, 10
    s_cbranch_scc1 L_p95
    s_waitcnt vmcnt(2)
L_p95:
    buffer_load_dwordx4 v[192:195], v1, s[28:31], 0 offen offset:128 nt
    v_mfma_f32_16x16x32_bf16 v[48:51], v[12:15], v[236:239], v[48:51]
    s_cmp_lg_u32 s3, 7
    s_cbranch_scc1 L_ml3
    s_mov_b32 s81, 0
    s_nop 4
L_mlchk:
    v_cmp_ne_u32 vcc, s49, v27
    s_nop 1
    s_cmp_eq_u64 vcc, 0
    s_cbranch_scc1 L_mlok
    s_add_u32 s81, s81, 1
    s_cmp_ge_u32 s81, 100000
    s_cbranch_scc1 L_mlok
    buffer_load_dwordx4 v[24:27], v23, s[44:47], s85 offen sc1
    s_waitcnt vmcnt(0)
    s_branch L_mlchk
L_mlok:
    v_mov_b32 v26, v24
    v_max_f32_dpp v24, v24, v24 quad_perm:[1,0,3,2] row_mask:0xf bank_mask:0xf
    s_nop 1
    v_max_f32_dpp v24, v24, v24 quad_perm:[2,3,0,1] row_mask:0xf bank_mask:0xf
    v_sub_f32 v26, v26, v24
    v_exp_f32 v26, v26
    s_nop 0
    v_mul_f32 v25, v26, v25
    s_nop 1
    v_add_f32_dpp v25, v25, v25 quad_perm:[1,0,3,2] row_mask:0xf bank_mask:0xf
    s_nop 1
    v_add_f32_dpp v25, v25, v25 quad_perm:[2,3,0,1] row_mask:0xf bank_mask:0xf
    v_rcp_f32 v25, v25
    v_mov_b32 v26, 1
    v_mov_b32 v28, 0
    s_mov_b64 exec, 1
    ds_write_b128 v28, v[24:27] offset:47696
    s_mov_b64 exec, -1
L_ml3:
    buffer_load_dwordx4 v[180:183], v2, s[40:43], s12 offen
    s_add_u32 s12, s12, 7168
    s_waitcnt vmcnt(5)
    s_bitcmp0_b32 s61, 11
    s_cbranch_scc1 L_p96
    s_waitcnt vmcnt(4)
    s_bitcmp0_b32 s62, 11
    s_cbranch_scc1 L_p96
    s_waitcnt vmcnt(2)
L_p96:
    buffer_load_dwordx4 v[196:199], v1, s[28:31], 0 offen offset:256 nt
    s_add_u32 s71, s71, 3
    v_sub_u32 v3, s71, v3
    s_mov_b32 exec_lo, 0
    v_add_u32 v3, -5, v3
    s_mov_b32 exec_lo, -1
    v_cmp_gt_u32 vcc, 5, v3
    v_cmp_gt_u32 s[10:11], 4, v3
    s_bcnt1_i32_b32 s7, vcc_hi
    s_bcnt1_i32_b32 s11, s11
    s_mul_i32 s7, s7, 4294967290
    s_lshl3_add_u32 s7, s11, s7
    s_mul_i32 s7, s7, 16
    s_ashr_i32 s7, s7, 3
    s_bcnt1_i32_b32 s70, vcc_lo
    v_cmp_gt_u32 vcc, 3, v3
    s_bcnt1_i32_b32 s10, s10
    s_add_u32 s70, s70, s10
    s_bcnt1_i32_b32 s10, vcc_lo
    s_add_u32 s70, s70, s10
    s_sub_i32 s70, s70, 45
    s_mul_i32 s70, s70, 24
    s_add_i32 s70, s70, s7
    s_ashr_i32 s70, s70, 3
    s_min_i32 s70, s70, 72
    s_max_i32 s70, s70, -72
    s_lshl3_add_u32 s10, s63, s3
    s_sub_i32 s10, s10, s67
    s_sub_i32 s10, s10, s70
    s_ashr_i32 s10, s10, 3
    s_min_i32 s65, s10, 16
    s_max_i32 s65, s65, 0
    s_bfm_b32 s61, s65, 0
    s_mul_i32 s61, s61, 0x10001
    s_lshr_b32 s61, s61, s64
    s_sub_i32 s65, s10, 16
    s_max_i32 s65, s65, 0
    s_min_i32 s65, s65, 16
    s_bfm_b32 s62, s65, 0
    s_mul_i32 s62, s62, 0x10001
    s_lshr_b32 s62, s62, s64
    v_cvt_pk_bf16_f32 v11, v42, v42
    v_and_b32 v8, v11, v4
    v_and_b32 v9, v11, v5
    v_and_b32 v10, v11, v6
    v_and_b32 v11, v11, v7
    s_nop 1
    v_mfma_f32_16x16x32_bf16 v[56:59], v[8:11], v[240:243], v[56:59]
    s_waitcnt vmcnt(5)
    s_bitcmp0_b32 s61, 12
    s_cbranch_scc1 L_p97
    s_waitcnt vmcnt(3)
    s_bitcmp0_b32 s62, 12
    s_cbranch_scc1 L_p97
    s_waitcnt vmcnt(2)
L_p97:
    buffer_load_dwordx4 v[200:203], v1, s[28:31], 0 offen offset:0 nt
    v_mfma_f32_16x16x32_bf16 v[52:55], v[8:11], v[244:247], v[52:55]
    buffer_load_dwordx4 v[184:187], v2, s[40:43], s12 offen
    s_add_u32 s12, s12, 7168
    v_xor_b32 v1, 0x58a00, v1
    s_waitcnt vmcnt(5)
    s_bitcmp0_b32 s61, 13
    s_cbranch_scc1 L_p98
    s_waitcnt vmcnt(4)
    s_bitcmp0_b32 s62, 13
    s_cbranch_scc1 L_p98
    s_waitcnt vmcnt(2)
L_p98:
    buffer_load_dwordx4 v[204:207], v1, s[28:31], 0 offen offset:128 nt
    v_mfma_f32_16x16x32_bf16 v[48:51], v[8:11], v[248:251], v[48:51]
    s_waitcnt vmcnt(5)
    s_bitcmp0_b32 s61, 14
    s_cbranch_scc1 L_p99
    s_waitcnt vmcnt(3)
    s_bitcmp0_b32 s62, 14
    s_cbranch_scc1 L_p99
    s_waitcnt vmcnt(2)
L_p99:
    buffer_load_dwordx4 v[208:211], v1, s[28:31], 0 offen offset:256 nt
    v_cvt_pk_bf16_f32 v15, v43, v43
    v_and_b32 v12, v15, v4
    v_and_b32 v13, v15, v5
    v_and_b32 v14, v15, v6
    v_and_b32 v15, v15, v7
    s_nop 1
    v_mfma_f32_16x16x32_bf16 v[52:55], v[12:15], v[192:195], v[52:55]
    s_waitcnt vmcnt(4)
    s_bitcmp0_b32 s61, 15
    s_cbranch_scc1 L_p100
    s_waitcnt vmcnt(3)
    s_bitcmp0_b32 s62, 15
    s_cbranch_scc1 L_p100
    s_waitcnt vmcnt(1)
L_p100:
    buffer_load_dwordx4 v[212:215], v1, s[28:31], 0 offen offset:0 nt
    v_mfma_f32_16x16x32_bf16 v[56:59], v[12:15], v[196:199], v[56:59]
    buffer_load_dwordx4 v[188:191], v2, s[40:43], s12 offen
    s_add_u32 s12, s12, 7168
    v_xor_b32 v1, 0x38600, v1
    s_waitcnt vmcnt(5)
    s_bitcmp0_b32 s61, 0
    s_cbranch_scc1 L_p101
    s_waitcnt vmcnt(3)
    s_bitcmp0_b32 s62, 0
    s_cbranch_scc1 L_p101
    s_waitcnt vmcnt(2)
L_p101:
    buffer_load_dwordx4 v[216:219], v1, s[28:31], 0 offen offset:256 nt
    s_lshl_b32 s71, s49, 8
    s_add_u32 s71, s71, 7
    v_mov_b32 v227, s71
    v_and_b32 v3, 63, v0
    v_lshlrev_b32 v3, 2, v3
    s_mov_b32 exec_lo, 0
    v_add_u32 v3, s21, v3
    s_mov_b64 exec, 1
    buffer_store_dword v227, off, s[44:47], s18
    s_mov_b64 exec, -1
    buffer_load_dword v3, v3, s[44:47], s16 offen
    v_mfma_f32_16x16x32_bf16 v[48:51], v[12:15], v[200:203], v[48:51]
    v_mov_b32 v252, 0
    v_mov_b32 v253, 0
    v_mov_b32 v254, 0
    v_mov_b32 v255, 0
    v_and_b32 v32, 3, v0
    v_mul_u32_u24 v32, 0x5555, v32
    v_bfe_i32 v34, v0, 2, 1
    v_and_b32 v34, 0xffff, v34
    v_xor_b32 v33, 0xffff, v34
    s_lshr_b32 s86, s3, 2
    v_lshl_add_u32 v22, s86, 8, v17
    v_lshl_add_u32 v23, s3, 2, v19
    v_and_b32 v35, 16, v33
    v_and_b32 v36, 16, v34
    s_waitcnt vmcnt(6)
    s_bitcmp0_b32 s61, 1
    s_cbranch_scc1 L_p102
    s_waitcnt vmcnt(5)
    s_bitcmp0_b32 s62, 1
    s_cbranch_scc1 L_p102
    s_waitcnt vmcnt(4)
L_p102:
    buffer_load_dwordx4 v[220:223], v1, s[28:31], 0 offen offset:128 nt
    v_cvt_pk_bf16_f32 v11, v44, v44
    v_and_b32 v8, v11, v4
    v_and_b32 v9, v11, v5
    v_and_b32 v10, v11, v6
    v_and_b32 v11, v11, v7
    s_nop 1
    v_mfma_f32_16x16x32_bf16 v[52:55], v[8:11], v[204:207], v[52:55]
    s_waitcnt vmcnt(6)
    s_bitcmp0_b32 s61, 2
    s_cbranch_scc1 L_p103
    s_waitcnt vmcnt(5)
    s_bitcmp0_b32 s62, 2
    s_cbranch_scc1 L_p103
    s_waitcnt vmcnt(3)
L_p103:
    buffer_load_dwordx4 v[228:231], v1, s[28:31], 0 offen offset:0 nt
    v_mfma_f32_16x16x32_bf16 v[56:59], v[8:11], v[208:211], v[56:59]
    v_xor_b32 v1, 0x94600, v1
    s_waitcnt vmcnt(6)
    s_bitcmp0_b32 s61, 3
    s_cbranch_scc1 L_p104
    s_waitcnt vmcnt(4)
    s_bitcmp0_b32 s62, 3
    s_cbranch_scc1 L_p104
    s_waitcnt vmcnt(1)
L_p104:
    buffer_load_dwordx4 v[232:235], v1, s[28:31], 0 offen offset:256 nt
    v_mfma_f32_16x16x32_bf16 v[48:51], v[8:11], v[212:215], v[48:51]
    s_waitcnt vmcnt(5)
    s_bitcmp0_b32 s61, 4
    s_cbranch_scc1 L_p105
    s_waitcnt vmcnt(2)
    s_bitcmp0_b32 s62, 4
    s_cbranch_scc1 L_p105
    s_waitcnt vmcnt(1)
L_p105:
    buffer_load_dwordx4 v[236:239], v1, s[28:31], 0 offen offset:128 nt
    v_cvt_pk_bf16_f32 v15, v45, v45
    v_and_b32 v12, v15, v4
    v_and_b32 v13, v15, v5
    v_and_b32 v14, v15, v6
    v_and_b32 v15, v15, v7
    s_nop 1
    v_mfma_f32_16x16x32_bf16 v[56:59], v[12:15], v[216:219], v[56:59]
    s_waitcnt vmcnt(3)
    s_bitcmp0_b32 s61, 5
    s_cbranch_scc1 L_p106
    s_waitcnt vmcnt(2)
    s_bitcmp0_b32 s62, 5
    s_cbranch_scc1 L_p106
    s_waitcnt vmcnt(1)
L_p106:
    buffer_load_dwordx4 v[240:243], v1, s[28:31], 0 offen offset:0 nt
    s_add_u32 s71, s71, 3
    v_sub_u32 v3, s71, v3
    s_mov_b32 exec_lo, 0
    v_add_u32 v3, -6, v3
    s_mov_b32 exec_lo, -1
    v_cmp_gt_u32 vcc, 5, v3
    v_cmp_gt_u32 s[10:11], 4, v3
    s_bcnt1_i32_b32 s7, vcc_hi
    s_bcnt1_i32_b32 s11, s11
    s_mul_i32 s7, s7, 4294967290
    s_lshl3_add_u32 s7, s11, s7
    s_mul_i32 s7, s7, 16
    s_ashr_i32 s7, s7, 3
    s_bcnt1_i32_b32 s70, vcc_lo
    v_cmp_gt_u32 vcc, 3, v3
    s_bcnt1_i32_b32 s10, s10
    s_add_u32 s70, s70, s10
    s_bcnt1_i32_b32 s10, vcc_lo
    s_add_u32 s70, s70, s10
    s_sub_i32 s70, s70, 45
    s_mul_i32 s70, s70, 24
    s_add_i32 s70, s70, s7
    s_ashr_i32 s70, s70, 3
    s_min_i32 s70, s70, 72
    s_max_i32 s70, s70, -72
    s_lshl3_add_u32 s10, s63, s3
    s_sub_i32 s10, s10, s67
    s_sub_i32 s10, s10, s70
    s_ashr_i32 s10, s10, 3
    s_min_i32 s65, s10, 16
    s_max_i32 s65, s65, 0
    s_bfm_b32 s61, s65, 0
    s_mul_i32 s61, s61, 0x10001
    s_lshr_b32 s61, s61, s64
    s_sub_i32 s65, s10, 16
    s_max_i32 s65, s65, 0
    s_min_i32 s65, s65, 16
    s_bfm_b32 s62, s65, 0
    s_mul_i32 s62, s62, 0x10001
    s_lshr_b32 s62, s62, s64
    v_mfma_f32_16x16x32_bf16 v[52:55], v[12:15], v[220:223], v[52:55]
    v_xor_b32 v1, 0x38600, v1
    s_waitcnt vmcnt(3)
    s_bitcmp0_b32 s61, 6
    s_cbranch_scc1 L_p107
    s_waitcnt vmcnt(2)
    s_bitcmp0_b32 s62, 6
    s_cbranch_scc1 L_p107
    s_waitcnt vmcnt(1)
L_p107:
    buffer_load_dwordx4 v[244:247], v1, s[28:31], 0 offen offset:128 nt
    v_mfma_f32_16x16x32_bf16 v[48:51], v[12:15], v[228:231], v[48:51]
    v_mov_b32 v28, 0
    s_mov_b32 s81, 0
    s_nop 5
L_mf:
    ds_read_b128 v[24:27], v28 offset:47696
    s_waitcnt lgkmcnt(0)
    v_readfirstlane_b32 s86, v26
    s_nop 0
    s_cmp_lg_u32 s86, 0
    s_cbranch_scc1 L_mfok
    s_add_u32 s81, s81, 1
    s_cmp_lt_u32 s81, 4000000
    s_sleep 1
    s_cbranch_scc1 L_mf
L_mfok:
    v_sub_f32 v30, v29, v24
    v_exp_f32 v30, v30
    s_nop 0
    v_mul_f32 v30, v30, v25
    v_mul_f32 v41, v41, v30
    v_mul_f32 v42, v42, v30
    v_mul_f32 v43, v43, v30
    v_mul_f32 v44, v44, v30
    v_mul_f32 v45, v45, v30
    v_mul_f32 v46, v46, v30
    v_mul_f32 v47, v47, v30
    v_mul_f32 v48, v48, v30
    v_mul_f32 v49, v49, v30
    v_mul_f32 v50, v50, v30
    v_mul_f32 v51, v51, v30
    v_mul_f32 v52, v52, v30
    v_mul_f32 v53, v53, v30
    v_mul_f32 v54, v54, v30
    v_mul_f32 v55, v55, v30
    v_mul_f32 v56, v56, v30
    v_mul_f32 v57, v57, v30
    v_mul_f32 v58, v58, v30
    v_mul_f32 v59, v59, v30
    v_mul_f32 v60, v60, v30
    v_mul_f32 v61, v61, v30
    v_mul_f32 v62, v62, v30
    v_mul_f32 v63, v63, v30
    v_cvt_pk_bf16_f32 v41, v41, v41
    v_cvt_pk_bf16_f32 v42, v42, v42
    v_cvt_pk_bf16_f32 v43, v43, v43
    v_cvt_pk_bf16_f32 v44, v44, v44
    v_cvt_pk_bf16_f32 v45, v45, v45
    v_cvt_pk_bf16_f32 v46, v46, v46
    v_cvt_pk_bf16_f32 v47, v47, v47
    s_waitcnt vmcnt(3)
    s_bitcmp0_b32 s61, 7
    s_cbranch_scc1 L_p108
    s_waitcnt vmcnt(2)
    s_bitcmp0_b32 s62, 7
    s_cbranch_scc1 L_p108
    s_waitcnt vmcnt(1)
L_p108:
    buffer_load_dwordx4 v[248:251], v1, s[28:31], 0 offen offset:256 nt
    v_and_b32 v8, v46, v4
    v_and_b32 v9, v46, v5
    v_and_b32 v10, v46, v6
    v_and_b32 v11, v46, v7
    s_nop 1
    v_mfma_f32_16x16x32_bf16 v[56:59], v[8:11], v[232:235], v[56:59]
    s_waitcnt vmcnt(3)
    s_bitcmp0_b32 s61, 8
    s_cbranch_scc1 L_p109
    s_waitcnt vmcnt(2)
    s_bitcmp0_b32 s62, 8
    s_cbranch_scc1 L_p109
    s_waitcnt vmcnt(1)
L_p109:
    buffer_load_dwordx4 v[192:195], v1, s[28:31], 0 offen offset:0 nt
    v_mfma_f32_16x16x32_bf16 v[52:55], v[8:11], v[236:239], v[52:55]
    v_xor_b32 v1, 0x60c00, v1
    s_waitcnt vmcnt(3)
    s_bitcmp0_b32 s61, 9
    s_cbranch_scc1 L_p110
    s_waitcnt vmcnt(2)
    s_bitcmp0_b32 s62, 9
    s_cbranch_scc1 L_p110
    s_waitcnt vmcnt(1)
L_p110:
    buffer_load_dwordx4 v[196:199], v1, s[28:31], 0 offen offset:384 nt
    v_mfma_f32_16x16x32_bf16 v[48:51], v[8:11], v[240:243], v[48:51]
    v_xor_b32 v1, 0x94600, v1
    s_waitcnt vmcnt(3)
    s_bitcmp0_b32 s61, 10
    s_cbranch_scc1 L_p111
    s_waitcnt vmcnt(2)
    s_bitcmp0_b32 s62, 10
    s_cbranch_scc1 L_p111
    s_waitcnt vmcnt(1)
L_p111:
    buffer_load_dwordx4 v[200:203], v1, s[28:31], 0 offen offset:384 nt
    v_and_b32 v12, v47, v4
    v_and_b32 v13, v47, v5
    v_and_b32 v14, v47, v6
    v_and_b32 v15, v47, v7
    s_nop 1
    v_mfma_f32_16x16x32_bf16 v[52:55], v[12:15], v[244:247], v[52:55]
    s_lshr_b32 s22, 255, s3
    s_and_b32 s22, s22, 1
    v_xor_b32 v1, 0x38600, v1
    buffer_load_dwordx4 v[204:207], v1, s[28:31], 0 offen offset:384 nt
    s_waitcnt vmcnt(4)
    v_mfma_f32_16x16x32_bf16 v[56:59], v[12:15], v[248:251], v[56:59]
    s_waitcnt vmcnt(3)
    v_mfma_f32_16x16x32_bf16 v[48:51], v[12:15], v[192:195], v[48:51]
    s_mov_b64 exec, s[72:73]
    s_nop 6
    ds_write_b128 v16, v[48:51] offset:0
    ds_write_b128 v16, v[52:55] offset:256
    ds_write_b128 v16, v[56:59] offset:512
    s_mov_b64 exec, -1
    s_mov_b64 vcc, s[72:73]
    s_waitcnt lgkmcnt(0)
    s_barrier
    ds_read_b64 v[48:49], v22 offset:0
    ds_read_b64 v[50:51], v22 offset:8704
    ds_read_b64 v[56:57], v17 offset:512
    ds_read_b64 v[58:59], v17 offset:9216
    v_xor_b32 v1, 0x58a00, v1
    buffer_load_dwordx4 v[208:211], v1, s[28:31], 0 offen offset:384 nt
    v_xor_b32 v1, 0x38600, v1
    buffer_load_dwordx4 v[212:215], v1, s[28:31], 0 offen offset:384 nt
    v_xor_b32 v1, 0x94600, v1
    buffer_load_dwordx4 v[216:219], v1, s[28:31], 0 offen offset:384 nt
    v_xor_b32 v1, 0x38600, v1
    buffer_load_dwordx4 v[220:223], v1, s[28:31], 0 offen offset:384 nt
    s_waitcnt lgkmcnt(0)
    v_pk_add_f32 v[48:49], v[48:49], v[50:51]
    v_pk_add_f32 v[56:57], v[56:57], v[58:59]
    s_nop 0
    v_add_f32_dpp v48, v48, v48 quad_perm:[1,0,3,2] row_mask:0xf bank_mask:0xf
    v_add_f32_dpp v49, v49, v49 quad_perm:[1,0,3,2] row_mask:0xf bank_mask:0xf
    v_add_f32_dpp v56, v56, v56 quad_perm:[1,0,3,2] row_mask:0xf bank_mask:0xf
    v_add_f32_dpp v57, v57, v57 quad_perm:[1,0,3,2] row_mask:0xf bank_mask:0xf
    v_add_f32_dpp v48, v48, v48 quad_perm:[2,3,0,1] row_mask:0xf bank_mask:0xf
    v_add_f32_dpp v49, v49, v49 quad_perm:[2,3,0,1] row_mask:0xf bank_mask:0xf
    v_add_f32_dpp v56, v56, v56 quad_perm:[2,3,0,1] row_mask:0xf bank_mask:0xf
    v_add_f32_dpp v57, v57, v57 quad_perm:[2,3,0,1] row_mask:0xf bank_mask:0xf
    v_add_f32_dpp v48, v48, v48 row_half_mirror row_mask:0xf bank_mask:0xf
    v_add_f32_dpp v49, v49, v49 row_half_mirror row_mask:0xf bank_mask:0xf
    v_add_f32_dpp v56, v56, v56 row_half_mirror row_mask:0xf bank_mask:0xf
    v_add_f32_dpp v57, v57, v57 row_half_mirror row_mask:0xf bank_mask:0xf
    v_cvt_pk_bf16_f32 v48, v48, v49
    v_cvt_pk_bf16_f32 v56, v56, v57
    s_mov_b64 exec, s[76:77]
    ds_write_b32 v23, v48
    ds_write_b32 v18, v56 offset:32
    s_mov_b64 exec, -1
    s_waitcnt lgkmcnt(0)
    s_barrier
    ds_read_b128 v[228:231], v19 offset:0
    ds_read_b128 v[232:235], v19 offset:16
    ds_read_b128 v[236:239], v19 offset:32
    s_mov_b32 s82, 0x07060503
    s_mov_b32 s83, 0x07060502
    s_mov_b32 s84, 0x07060501
    s_waitcnt lgkmcnt(0)
    v_and_b32 v48, v228, v33
    v_and_b32 v49, v228, v34
    v_bfe_u32 v50, v228, 16, v35
    v_bfe_u32 v51, v228, 16, v36
    v_and_b32 v52, v229, v33
    v_and_b32 v53, v229, v34
    v_bfe_u32 v54, v229, 16, v35
    v_bfe_u32 v55, v229, 16, v36
    v_smfmac_f32_16x16x64_bf16 v[252:255], v[48:51], v[64:71], v32
    v_and_b32 v56, v230, v33
    v_and_b32 v57, v230, v34
    v_bfe_u32 v58, v230, 16, v35
    v_bfe_u32 v59, v230, 16, v36
    v_smfmac_f32_16x16x64_bf16 v[252:255], v[52:55], v[72:79], v32
    v_and_b32 v48, v231, v33
    v_and_b32 v49, v231, v34
    v_bfe_u32 v50, v231, 16, v35
    v_bfe_u32 v51, v231, 16, v36
    v_smfmac_f32_16x16x64_bf16 v[252:255], v[56:59], v[80:87], v32
    v_and_b32 v52, v232, v33
    v_and_b32 v53, v232, v34
    v_bfe_u32 v54, v232, 16, v35
    v_bfe_u32 v55, v232, 16, v36
    v_smfmac_f32_16x16x64_bf16 v[252:255], v[48:51], v[88:95], v32
    v_and_b32 v56, v233, v33
    v_and_b32 v57, v233, v34
    v_bfe_u32 v58, v233, 16, v35
    v_bfe_u32 v59, v233, 16, v36
    v_smfmac_f32_16x16x64_bf16 v[252:255], v[52:55], v[96:103], v32
    v_and_b32 v48, v234, v33
    v_and_b32 v49, v234, v34
    v_bfe_u32 v50, v234, 16, v35
    v_bfe_u32 v51, v234, 16, v36
    v_smfmac_f32_16x16x64_bf16 v[252:255], v[56:59], v[104:111], v32
    v_and_b32 v52, v235, v33
    v_and_b32 v53, v235, v34
    v_bfe_u32 v54, v235, 16, v35
    v_bfe_u32 v55, v235, 16, v36
    v_smfmac_f32_16x16x64_bf16 v[252:255], v[48:51], v[112:119], v32
    v_and_b32 v56, v236, v33
    v_and_b32 v57, v236, v34
    v_bfe_u32 v58, v236, 16, v35
    v_bfe_u32 v59, v236, 16, v36
    v_smfmac_f32_16x16x64_bf16 v[252:255], v[52:55], v[120:127], v32
    v_and_b32 v48, v237, v33
    v_and_b32 v49, v237, v34
    v_bfe_u32 v50, v237, 16, v35
    v_bfe_u32 v51, v237, 16, v36
    v_smfmac_f32_16x16x64_bf16 v[252:255], v[56:59], v[128:135], v32
    v_and_b32 v52, v238, v33
    v_and_b32 v53, v238, v34
    v_bfe_u32 v54, v238, 16, v35
    v_bfe_u32 v55, v238, 16, v36
    v_smfmac_f32_16x16x64_bf16 v[252:255], v[48:51], v[136:143], v32
    v_and_b32 v56, v239, v33
    v_and_b32 v57, v239, v34
    v_bfe_u32 v58, v239, 16, v35
    v_bfe_u32 v59, v239, 16, v36
    v_smfmac_f32_16x16x64_bf16 v[252:255], v[52:55], v[144:151], v32
    s_nop 0
    v_smfmac_f32_16x16x64_bf16 v[252:255], v[56:59], v[152:159], v32
    s_nop 7
L_e1:
    v_and_b32 v12, v41, v4
    v_and_b32 v13, v41, v5
    v_and_b32 v14, v41, v6
    v_and_b32 v15, v41, v7
    s_waitcnt vmcnt(6)
    s_nop 0
    v_mfma_f32_16x16x32_bf16 v[60:63], v[12:15], v[196:199], v[60:63]
    v_and_b32 v8, v42, v4
    v_and_b32 v9, v42, v5
    v_and_b32 v10, v42, v6
    v_and_b32 v11, v42, v7
    s_waitcnt vmcnt(5)
    s_nop 0
    v_mfma_f32_16x16x32_bf16 v[60:63], v[8:11], v[200:203], v[60:63]
    v_and_b32 v12, v43, v4
    v_and_b32 v13, v43, v5
    v_and_b32 v14, v43, v6
    v_and_b32 v15, v43, v7
    s_waitcnt vmcnt(4)
    s_nop 0
    v_mfma_f32_16x16x32_bf16 v[60:63], v[12:15], v[204:207], v[60:63]
    v_and_b32 v8, v44, v4
    v_and_b32 v9, v44, v5
    v_and_b32 v10, v44, v6
    v_and_b32 v11, v44, v7
    s_waitcnt vmcnt(3)
    s_nop 0
    v_mfma_f32_16x16x32_bf16 v[60:63], v[8:11], v[208:211], v[60:63]
    v_and_b32 v12, v45, v4
    v_and_b32 v13, v45, v5
    v_and_b32 v14, v45, v6
    v_and_b32 v15, v45, v7
    s_waitcnt vmcnt(2)
    s_nop 0
    v_mfma_f32_16x16x32_bf16 v[60:63], v[12:15], v[212:215], v[60:63]
    v_and_b32 v8, v46, v4
    v_and_b32 v9, v46, v5
    v_and_b32 v10, v46, v6
    v_and_b32 v11, v46, v7
    s_waitcnt vmcnt(1)
    s_nop 0
    v_mfma_f32_16x16x32_bf16 v[60:63], v[8:11], v[216:219], v[60:63]
    v_and_b32 v12, v47, v4
    v_and_b32 v13, v47, v5
    v_and_b32 v14, v47, v6
    v_and_b32 v15, v47, v7
    s_mov_b64 exec, s[72:73]
    s_waitcnt vmcnt(0)
    v_mfma_f32_16x16x32_bf16 v[60:63], v[12:15], v[220:223], v[60:63]
    s_nop 7
    ds_write_b128 v16, v[60:63] offset:768
    s_mov_b64 exec, -1
    s_cmp_ge_u32 s3, 4
    s_waitcnt lgkmcnt(0)
    s_barrier
    s_cbranch_scc1 L_c4
    ds_read_b64 v[48:49], v17 offset:768
    ds_read_b64 v[50:51], v17 offset:9472
    s_waitcnt lgkmcnt(0)
    v_pk_add_f32 v[48:49], v[48:49], v[50:51]
    s_nop 1
    v_add_f32_dpp v48, v48, v48 quad_perm:[1,0,3,2] row_mask:0xf bank_mask:0xf
    v_add_f32_dpp v49, v49, v49 quad_perm:[1,0,3,2] row_mask:0xf bank_mask:0xf
    s_nop 0
    v_add_f32_dpp v48, v48, v48 quad_perm:[2,3,0,1] row_mask:0xf bank_mask:0xf
    v_add_f32_dpp v49, v49, v49 quad_perm:[2,3,0,1] row_mask:0xf bank_mask:0xf
    s_nop 0
    v_add_f32_dpp v48, v48, v48 row_half_mirror row_mask:0xf bank_mask:0xf
    v_add_f32_dpp v49, v49, v49 row_half_mirror row_mask:0xf bank_mask:0xf
    v_cvt_pk_bf16_f32 v48, v48, v49
    s_mov_b64 exec, s[76:77]
    ds_write_b32 v18, v48 offset:48
    s_mov_b64 exec, -1
    s_branch L_c5
L_c4:
    s_cmp_eq_u32 s3, 7
    s_cbranch_scc1 L_upper
L_c5:
    v_mov_b32 v11, s49
    s_waitcnt lgkmcnt(0)
    s_barrier
    ds_read_b128 v[240:243], v19 offset:48
    s_waitcnt lgkmcnt(0)
    v_and_b32 v48, v240, v33
    v_and_b32 v49, v240, v34
    v_bfe_u32 v50, v240, 16, v35
    v_bfe_u32 v51, v240, 16, v36
    v_and_b32 v52, v241, v33
    v_and_b32 v53, v241, v34
    v_bfe_u32 v54, v241, 16, v35
    v_bfe_u32 v55, v241, 16, v36
    v_smfmac_f32_16x16x64_bf16 v[252:255], v[48:51], v[160:167], v32
    v_and_b32 v56, v242, v33
    v_and_b32 v57, v242, v34
    v_bfe_u32 v58, v242, 16, v35
    v_bfe_u32 v59, v242, 16, v36
    v_smfmac_f32_16x16x64_bf16 v[252:255], v[52:55], v[168:175], v32
    v_and_b32 v48, v243, v33
    v_and_b32 v49, v243, v34
    v_bfe_u32 v50, v243, 16, v35
    v_bfe_u32 v51, v243, 16, v36
    v_smfmac_f32_16x16x64_bf16 v[252:255], v[56:59], v[176:183], v32
    s_nop 0
    v_smfmac_f32_16x16x64_bf16 v[252:255], v[48:51], v[184:191], v32
    s_nop 7
    v_permlane32_swap_b32 v252, v254
    v_permlane32_swap_b32 v253, v255
    s_nop 0
    v_add_f32_dpp v252, v254, v252 row_ror:8 row_mask:0xf bank_mask:0xf
    v_add_f32_dpp v253, v255, v253 row_ror:8 row_mask:0xf bank_mask:0xf
    s_nop 1
    v_permlane32_swap_b32 v253, v255
    v_permlane32_swap_b32 v252, v254
    s_mov_b64 exec, s[74:75]
    v_perm_b32 v8, v252, v255, s82
    v_perm_b32 v9, v253, v255, s83
    v_perm_b32 v10, v254, v255, s84
    buffer_store_dwordx4 v[8:11], v20, s[44:47], s89 offen sc1
    s_mov_b64 exec, -1
    s_endpgm
L_bend:
    s_barrier
    s_endpgm
L_upper:
    s_cmp_lg_u32 s3, 7
L_t3:
    s_cbranch_execz L_r3
    s_cbranch_scc1 L_bend
    s_cmp_ge_u32 s80, 28
    s_cbranch_scc1 L_bend
    s_add_u32 s56, s88, 4096
    buffer_load_dwordx4 v[32:35], v21, s[44:47], s88 offen offset:0 sc1
    s_mov_b32 s81, 0
    s_mov_b32 s82, 0x04000c0c
    s_mov_b32 s83, 0x0706000c
    v_and_b32 v24, 3, v0
    v_lshlrev_b32 v24, 3, v24
    v_bfe_u32 v25, v0, 4, 2
    v_lshl_add_u32 v24, v25, 1, v24
    s_and_b32 s84, s79, 1
    s_mul_i32 s84, s84, 1792
    s_mul_i32 s85, s50, 896
    s_add_u32 s84, s84, s85
    s_lshl_b32 s85, s80, 5
    s_add_u32 s84, s84, s85
    s_mov_b32 s76, 0x000f000f
    s_mov_b32 s77, 0x000f000f
    s_barrier
L_h:
    s_waitcnt vmcnt(0)
    v_cmp_ne_u32 vcc, s49, v35
    s_add_u32 s81, s81, 1
    s_bcnt1_i32_b64 s86, vcc
    s_cmp_le_u32 s86, 16
    s_cbranch_scc1 L_hgo
    s_mov_b64 exec, vcc
    buffer_load_dwordx4 v[32:35], v21, s[44:47], s88 offen offset:0 sc1
    s_cmp_lt_u32 s81, 100000
    s_cbranch_scc1 L_h
L_hgo:
    s_mov_b64 exec, -1
    buffer_load_dwordx4 v[32:35], v21, s[44:47], s88 offen offset:0 sc1
    buffer_load_dwordx4 v[36:39], v21, s[44:47], s88 offen offset:2048 sc1
    buffer_load_dwordx4 v[40:43], v21, s[44:47], s56 offen offset:0 sc1
    buffer_load_dwordx4 v[44:47], v21, s[44:47], s56 offen offset:2048 sc1
L_poll:
    s_waitcnt vmcnt(0)
    v_max3_u32 v25, v35, v39, v43
    v_min3_u32 v26, v35, v39, v43
    v_max3_u32 v25, v25, v47, s49
    v_min3_u32 v26, v26, v47, s49
    v_cmp_ne_u32 vcc, v25, v26
    s_nop 1
    s_cmp_eq_u64 vcc, 0
    s_cbranch_scc1 L_poll_ok
    s_mov_b64 exec, vcc
    buffer_load_dwordx4 v[32:35], v21, s[44:47], s88 offen offset:0 sc1
    buffer_load_dwordx4 v[36:39], v21, s[44:47], s88 offen offset:2048 sc1
    buffer_load_dwordx4 v[40:43], v21, s[44:47], s56 offen offset:0 sc1
    buffer_load_dwordx4 v[44:47], v21, s[44:47], s56 offen offset:2048 sc1
    s_add_u32 s81, s81, 1
    s_cmp_lt_u32 s81, 100000
    s_cbranch_scc1 L_poll
    s_waitcnt vmcnt(0)
L_poll_ok:
    s_mov_b64 exec, -1
    v_perm_b32 v35, v32, v33, s82
    v_perm_b32 v39, v36, v37, s82
    v_perm_b32 v43, v40, v41, s82
    v_perm_b32 v47, v44, v45, s82
    v_perm_b32 v35, v35, v34, s83
    v_perm_b32 v39, v39, v38, s83
    v_perm_b32 v43, v43, v42, s83
    v_perm_b32 v47, v47, v46, s83
    v_pk_add_f32 v[32:33], v[32:33], v[36:37]
    v_pk_add_f32 v[34:35], v[34:35], v[38:39]
    v_pk_add_f32 v[40:41], v[40:41], v[44:45]
    v_pk_add_f32 v[42:43], v[42:43], v[46:47]
    v_pk_add_f32 v[32:33], v[32:33], v[40:41]
    v_pk_add_f32 v[34:35], v[34:35], v[42:43]
    s_nop 1
    v_permlane32_swap_b32 v32, v34
    v_permlane32_swap_b32 v33, v35
    v_add_f32 v32, v32, v34
    v_add_f32 v33, v33, v35
    s_nop 1
    v_permlane16_swap_b32 v32, v33
    v_add_f32 v32, v32, v33
    s_nop 1
    v_add_f32_dpp v32, v32, v32 row_ror:8 row_mask:0xf bank_mask:0xf
    s_nop 1
    v_add_f32_dpp v32, v32, v32 row_ror:4 row_mask:0xf bank_mask:0xf
    v_cvt_pk_bf16_f32 v32, v32, v32
    s_mov_b64 exec, s[76:77]
    buffer_store_short v32, v24, s[52:55], s84 offen
    s_mov_b64 exec, -1
    s_and_b32 s82, s79, 1
    s_or_b32 s82, s82, s80
    s_cbranch_scc1 L_end
    s_add_u32 s48, s48, 1
    s_lshl_b32 s82, s50, 7
    s_add_u32 s82, s82, 655360
    v_mov_b32 v25, s48
    v_mov_b32 v24, 0
    s_mov_b64 exec, 1
    buffer_store_dword v25, v24, s[44:47], s82 offen sc1
    s_mov_b64 exec, -1
L_end:
    s_endpgm
.section .rodata,"a"
.p2align 6
.amdhsa_kernel concat_heads__mha_block_cached__mha_block_cached__decode_kernel
  .amdhsa_next_free_vgpr 256
  .amdhsa_next_free_sgpr 102
  .amdhsa_accum_offset 256
  .amdhsa_group_segment_fixed_size 0
  .amdhsa_kernarg_size 104
  .amdhsa_user_sgpr_count 2
  .amdhsa_user_sgpr_kernarg_segment_ptr 1
  .amdhsa_system_sgpr_workgroup_id_x 1
  .amdhsa_float_denorm_mode_32 3
.end_amdhsa_kernel
```
